```python
import torch

def _softmax(x, axis=-1):
    return torch.softmax(x, dim=axis)
def _gelu(x):
    return torch.nn.functional.gelu(x, approximate="tanh")
def _silu(x):
    return torch.nn.functional.silu(x)
def _sigmoid(x):
    return torch.sigmoid(x)
def _layernorm(x, axis=-1, eps=1e-5):
    m = x.mean(dim=axis, keepdim=True)
    v = x.var(dim=axis, keepdim=True, unbiased=False)
    return (x - m) / torch.sqrt(v + eps)
def _scatter_add(tgt, idx, src, axis=0):
    return tgt.clone().index_add_(axis, idx, src)
def _segment_sum(src, seg, n):
    out = torch.zeros((n,) + src.shape[1:], dtype=src.dtype)
    return out.index_add_(0, seg, src)
def _pad(x, pw):
    flat = tuple(v for pair in reversed(pw) for v in pair)
    return torch.nn.functional.pad(x, flat)

kernel_name = 'standalone__gqa_block_cached__near_ridge'

def setup_inputs():

    _w = (lambda a: (lambda t: t.to(torch.bfloat16) if t.is_floating_point() else t)(torch.as_tensor(a)))
    B, Sq, D = 8, 112, 576
    Hq, Hkv, Sk, Dh = 32, 16, 512, 128
    assert Hq % Hkv == 0, (Hq, Hkv)
    return {
        "x": _w((lambda *s: torch.randn(*s, dtype=torch.bfloat16) * 0.8)(B, Sq, D)),
        "k_cache": _w((lambda *s: torch.randn(*s, dtype=torch.bfloat16) * 0.8)(B, Hkv, Sk, Dh)),
        "v_cache": _w((lambda *s: torch.randn(*s, dtype=torch.bfloat16) * 0.05)(B, Hkv, Sk, Dh)),
        "wq": _w((lambda *s: torch.randn(*s, dtype=torch.bfloat16) * 0.8)(D, Hq * Dh) * (D ** -0.5)),
        "wo": _w((lambda *s: torch.randn(*s, dtype=torch.bfloat16) * 0.05)(Hq * Dh, D) * ((Hq * Dh) ** -0.5)),
    }

def reference(x, k_cache, v_cache, wq, wo):
    B, Sq, D = x.shape
    Hq, Dh = 32, 128
    Hkv = k_cache.shape[1]
    rep = Hq // Hkv
    q = (lambda x, *d: x.permute(*d))((x @ wq).reshape(B, Sq, Hq, Dh), 0, 2, 1, 3)
    k = (lambda x, n, axis: torch.repeat_interleave(x, n, dim=axis))(k_cache, rep, axis=1)
    v = (lambda x, n, axis: torch.repeat_interleave(x, n, dim=axis))(v_cache, rep, axis=1)
    scores = torch.einsum("bhqd,bhkd->bhqk", q, k) * (Dh ** -0.5)
    p = _softmax(scores, axis=-1)
    o = torch.einsum("bhqk,bhkd->bhqd", p, v)
    return (lambda x, *d: x.permute(*d))(o, 0, 2, 1, 3).reshape(B, Sq, Hq * Dh) @ wo
```

```asm
; @launch kernel=gqa_attn_kernel grid=(256,1,1) block=(512,1,1) lds=163840
; @launch kernel=gqa_oproj_kernel grid=(256,1,1) block=(1024,1,1) lds=163840
.amdgcn_target "amdgcn-amd-amdhsa--gfx950"
.text
.globl gqa_attn_kernel
.p2align 8
.type gqa_attn_kernel,@function
gqa_attn_kernel:
    s_cmp_ge_u32 s2, 256
    s_cbranch_scc1 gqa_attn_kernel_done
    s_load_dwordx8 s[4:11], s[0:1], 0
    s_load_dwordx4 s[12:15], s[0:1], 32
    s_load_dwordx4 s[16:19], s[0:1], 48
    s_and_b32 s40, s2, 7
    s_lshr_b32 s41, s2, 3
    s_lshr_b32 s42, s41, 2
    s_and_b32 s43, s41, 3
    s_lshl_b32 s44, s40, 2
    s_add_u32 s44, s44, s43
    s_lshr_b32 s45, s44, 1
    v_lshrrev_b32 v220, 6, v0
    v_and_b32 v221, 63, v0
    v_readfirstlane_b32 s46, v220
    v_and_b32 v222, 31, v221
    v_lshrrev_b32 v223, 5, v221
    v_bfe_u32 v224, v221, 4, 1
    v_and_b32 v225, 15, v221
    v_bfe_u32 v226, v221, 2, 2
    v_and_b32 v227, 3, v221
    v_lshrrev_b32 v228, 4, v221
    s_and_b32 s57, s46, 3
    s_lshr_b32 s58, s46, 2
    s_lshl_b32 s47, s44, 8
    s_lshl_b32 s52, s42, 4
    s_add_u32 s52, s52, s45
    s_lshl_b32 s48, s52, 17
    s_lshl_b32 s49, s46, 11
    s_mov_b32 s51, 0x3e0293ee
    s_mul_i32 s56, s42, 129024
    s_lshl_b32 s53, s46, 3
    v_add_u32 v136, s53, v228
    v_lshlrev_b32 v137, 2, v228
    v_xor_b32 v137, v137, v225
    v_lshlrev_b32 v137, 4, v137
    v_lshl_add_u32 v207, v136, 13, v137
    v_lshl_add_u32 v206, v136, 8, v137
    v_add_u32 v137, 0, v136
    v_and_b32 v137, 15, v137
    v_xor_b32 v137, v137, v225
    v_lshlrev_b32 v137, 4, v137
    v_lshl_add_u32 v204, v136, 8, v137
    v_add_u32 v137, 4, v136
    v_and_b32 v137, 15, v137
    v_xor_b32 v137, v137, v225
    v_lshlrev_b32 v137, 4, v137
    v_lshl_add_u32 v205, v136, 8, v137
    v_lshrrev_b32 v136, 3, v221
    s_lshl_b32 s53, s46, 4
    v_add_u32 v136, s53, v136
    s_movk_i32 s55, 1152
    v_mul_lo_u32 v136, v136, s55
    v_and_b32 v138, 7, v221
    v_add_u32 v137, 0, v228
    v_xor_b32 v137, v137, v138
    v_lshl_add_u32 v208, v137, 4, v136
    v_add_u32 v137, 4, v228
    v_xor_b32 v137, v137, v138
    v_lshl_add_u32 v209, v137, 4, v136
    v_add_u32 v209, 9216, v209
    s_waitcnt lgkmcnt(0)
    s_mov_b32 s20, s4
    s_and_b32 s21, s5, 0xffff
    s_mov_b32 s22, 1032192
    s_mov_b32 s23, 0x00020000
    s_mov_b32 s32, s10
    s_and_b32 s33, s11, 0xffff
    s_mov_b32 s34, 4718592
    s_mov_b32 s35, 0x00020000
    s_mov_b32 s24, s6
    s_and_b32 s25, s7, 0xffff
    s_mov_b32 s26, 16777216
    s_mov_b32 s27, 0x00020000
    s_mov_b32 s28, s8
    s_and_b32 s29, s9, 0xffff
    s_mov_b32 s30, 16777216
    s_mov_b32 s31, 0x00020000
    s_mov_b32 s36, s18
    s_and_b32 s37, s19, 0xffff
    s_mov_b32 s38, 7340032
    s_mov_b32 s39, 0x00020000
    s_add_u32 s50, s56, 0
    s_add_u32 m0, s49, 0x20000
    s_nop 0
    buffer_load_dwordx4 v208, s[20:23], s50 offen lds
    s_add_u32 s50, s56, 0
    s_add_u32 m0, s49, 0x20400
    s_nop 0
    buffer_load_dwordx4 v209, s[20:23], s50 offen lds
    s_add_u32 s50, s47, 0x0
    s_add_u32 m0, s49, 0x24000
    s_nop 0
    buffer_load_dwordx4 v207, s[32:35], s50 offen lds
    s_add_u32 s50, s47, 0x8000
    s_add_u32 m0, s49, 0x24400
    s_nop 0
    buffer_load_dwordx4 v207, s[32:35], s50 offen lds
    s_lshl_b32 s53, s57, 5
    v_add_u32 v136, s53, v222
    v_lshrrev_b32 v137, 4, v136
    s_mul_i32 s54, s42, 7
    v_add_u32 v137, s54, v137
    v_lshlrev_b32 v137, 7, v137
    s_lshl_b32 s54, s44, 2
    s_lshl_b32 s55, s58, 1
    s_add_u32 s54, s54, s55
    v_add_u32 v137, s54, v137
    v_lshlrev_b32 v137, 2, v137
    v_add_u32 v137, v137, v223
    v_lshlrev_b32 v137, 8, v137
    v_lshl_add_u32 v137, v225, 4, v137
    v_mov_b32 v138, 0x40000000
    v_cmp_gt_u32 vcc, 112, v136
    s_nop 1
    v_cndmask_b32 v210, v138, v137, vcc
    v_bfe_u32 v137, v136, 1, 3
    v_xor_b32 v137, v137, v223
    v_lshlrev_b32 v137, 4, v137
    v_lshl_add_u32 v98, v136, 7, v137
    s_add_u32 s50, s56, 128
    s_add_u32 m0, s49, 0x18000
    s_nop 0
    buffer_load_dwordx4 v208, s[20:23], s50 offen lds
    s_lshl_b32 s59, s58, 15
    s_mul_i32 s60, s58, 49152
    v_and_b32 v136, 15, v222
    v_xor_b32 v136, v136, v223
    v_lshlrev_b32 v136, 4, v136
    v_lshl_add_u32 v136, v222, 8, v136
    v_add_u32 v136, s60, v136
    v_xor_b32 v192, 0, v136
    v_xor_b32 v193, 32, v136
    v_xor_b32 v194, 64, v136
    v_xor_b32 v195, 96, v136
    v_xor_b32 v196, 128, v136
    v_xor_b32 v197, 160, v136
    v_xor_b32 v198, 192, v136
    v_xor_b32 v199, 224, v136
    s_add_u32 s50, s56, 128
    s_add_u32 m0, s49, 0x18400
    s_nop 0
    buffer_load_dwordx4 v209, s[20:23], s50 offen lds
    v_lshl_add_u32 v136, v223, 2, v226
    v_lshlrev_b32 v136, 8, v136
    v_lshl_add_u32 v136, v224, 5, v136
    v_lshl_add_u32 v136, v227, 3, v136
    v_add_u32 v136, 0x18000, v136
    v_add_u32 v136, s59, v136
    v_xor_b32 v137, 0, v226
    v_lshl_add_u32 v200, v137, 6, v136
    v_xor_b32 v137, 1, v226
    v_lshl_add_u32 v201, v137, 6, v136
    v_xor_b32 v137, 2, v226
    v_lshl_add_u32 v202, v137, 6, v136
    v_xor_b32 v137, 3, v226
    v_lshl_add_u32 v203, v137, 6, v136
    s_add_u32 s50, s47, 0x80000
    s_add_u32 m0, s49, 0x1c000
    s_nop 0
    buffer_load_dwordx4 v207, s[32:35], s50 offen lds
    s_add_u32 s50, s47, 0x88000
    s_add_u32 m0, s49, 0x1c400
    s_nop 0
    buffer_load_dwordx4 v207, s[32:35], s50 offen lds
    v_lshl_add_u32 v136, v223, 3, v226
    v_lshlrev_b32 v136, 8, v136
    v_lshl_add_u32 v136, v224, 5, v136
    v_and_b32 v137, 1, v227
    v_lshl_add_u32 v136, v137, 4, v136
    v_lshrrev_b32 v137, 1, v227
    v_lshl_add_u32 v136, v137, 3, v136
    s_lshl_b32 s55, s58, 1
    v_mov_b32 v138, s55
    v_add_u32 v138, 0, v138
    v_xor_b32 v137, v138, v226
    v_lshl_add_u32 v96, v137, 6, v136
    v_mov_b32 v138, s55
    v_add_u32 v138, 1, v138
    v_xor_b32 v137, v138, v226
    v_lshl_add_u32 v97, v137, 6, v136
    v_lshlrev_b32 v218, 4, v221
    v_lshlrev_b32 v219, 3, v221
    s_waitcnt vmcnt(6)
    s_waitcnt vmcnt(4)
    s_barrier
    v_add_u32 v100, 0x24000, v96
    v_add_u32 v101, 0x24000, v97
    v_xor_b32 v102, 0, v98
    v_add_u32 v102, 0x20000, v102
    v_xor_b32 v103, 32, v98
    v_add_u32 v103, 0x20000, v103
    v_xor_b32 v104, 64, v98
    v_add_u32 v104, 0x20000, v104
    v_xor_b32 v105, 96, v98
    v_add_u32 v105, 0x20000, v105
    ds_read_b128 v[112:115], v102
    ds_read_b64_tr_b16 v[160:161], v100 offset:0
    ds_read_b64_tr_b16 v[162:163], v100 offset:1024
    ds_read_b64_tr_b16 v[164:165], v101 offset:0
    ds_read_b64_tr_b16 v[166:167], v101 offset:1024
    ds_read_b128 v[116:119], v103
    ds_read_b64_tr_b16 v[168:169], v100 offset:4096
    ds_read_b64_tr_b16 v[170:171], v100 offset:5120
    ds_read_b64_tr_b16 v[172:173], v101 offset:4096
    ds_read_b64_tr_b16 v[174:175], v101 offset:5120
    ds_read_b128 v[120:123], v104
    ds_read_b64_tr_b16 v[176:177], v100 offset:8192
    ds_read_b64_tr_b16 v[178:179], v100 offset:9216
    s_setprio 3
    ds_read_b64_tr_b16 v[180:181], v101 offset:8192
    ds_read_b64_tr_b16 v[182:183], v101 offset:9216
    s_waitcnt lgkmcnt(12)
    v_mfma_f32_32x32x16_bf16 v[0:15], v[160:163], v[112:115], 0
    s_add_u32 s50, s56, 256
    s_add_u32 m0, s49, 0x4000
    s_nop 0
    buffer_load_dwordx4 v208, s[20:23], s50 offen lds
    s_setprio 2
    ds_read_b128 v[124:127], v105
    ds_read_b64_tr_b16 v[184:185], v100 offset:12288
    ds_read_b64_tr_b16 v[186:187], v100 offset:13312
    s_waitcnt lgkmcnt(13)
    v_mfma_f32_32x32x16_bf16 v[16:31], v[164:167], v[112:115], 0
    s_add_u32 s50, s56, 256
    s_add_u32 m0, s49, 0x4400
    s_nop 0
    buffer_load_dwordx4 v209, s[20:23], s50 offen lds
    s_setprio 1
    ds_read_b64_tr_b16 v[188:189], v101 offset:12288
    ds_read_b64_tr_b16 v[190:191], v101 offset:13312
    s_waitcnt lgkmcnt(12)
    v_mfma_f32_32x32x16_bf16 v[0:15], v[168:171], v[116:119], v[0:15]
    s_add_u32 s50, s47, 0x100000
    s_add_u32 m0, s49, 0x8000
    s_nop 0
    buffer_load_dwordx4 v207, s[32:35], s50 offen lds
    s_setprio 3
    s_waitcnt vmcnt(5)
    s_waitcnt vmcnt(3)
    s_barrier
    v_add_u32 v100, 0x1c000, v96
    v_add_u32 v101, 0x1c000, v97
    v_xor_b32 v102, 0, v98
    v_add_u32 v102, 0x18000, v102
    v_xor_b32 v103, 32, v98
    v_add_u32 v103, 0x18000, v103
    v_xor_b32 v104, 64, v98
    v_add_u32 v104, 0x18000, v104
    v_xor_b32 v105, 96, v98
    v_add_u32 v105, 0x18000, v105
    ds_read_b128 v[112:115], v102
    ds_read_b64_tr_b16 v[160:161], v100 offset:0
    ds_read_b64_tr_b16 v[162:163], v100 offset:1024
    s_waitcnt lgkmcnt(13)
    v_mfma_f32_32x32x16_bf16 v[16:31], v[172:175], v[116:119], v[16:31]
    s_add_u32 s50, s47, 0x108000
    s_add_u32 m0, s49, 0x8400
    s_nop 0
    buffer_load_dwordx4 v207, s[32:35], s50 offen lds
    ds_read_b64_tr_b16 v[164:165], v101 offset:0
    ds_read_b64_tr_b16 v[166:167], v101 offset:1024
    s_waitcnt lgkmcnt(12)
    v_mfma_f32_32x32x16_bf16 v[0:15], v[176:179], v[120:123], v[0:15]
    s_add_u32 s50, s56, 384
    s_add_u32 m0, s49, 0x10000
    s_nop 0
    buffer_load_dwordx4 v208, s[20:23], s50 offen lds
    s_setprio 2
    ds_read_b128 v[116:119], v103
    ds_read_b64_tr_b16 v[168:169], v100 offset:4096
    ds_read_b64_tr_b16 v[170:171], v100 offset:5120
    s_waitcnt lgkmcnt(13)
    v_mfma_f32_32x32x16_bf16 v[16:31], v[180:183], v[120:123], v[16:31]
    s_add_u32 s50, s56, 384
    s_add_u32 m0, s49, 0x10400
    s_nop 0
    buffer_load_dwordx4 v209, s[20:23], s50 offen lds
    ds_read_b64_tr_b16 v[172:173], v101 offset:4096
    ds_read_b64_tr_b16 v[174:175], v101 offset:5120
    s_waitcnt lgkmcnt(12)
    v_mfma_f32_32x32x16_bf16 v[0:15], v[184:187], v[124:127], v[0:15]
    s_add_u32 s50, s47, 0x180000
    s_add_u32 m0, s49, 0x14000
    s_nop 0
    buffer_load_dwordx4 v207, s[32:35], s50 offen lds
    s_setprio 1
    ds_read_b128 v[120:123], v104
    ds_read_b64_tr_b16 v[176:177], v100 offset:8192
    ds_read_b64_tr_b16 v[178:179], v100 offset:9216
    s_waitcnt lgkmcnt(13)
    v_mfma_f32_32x32x16_bf16 v[16:31], v[188:191], v[124:127], v[16:31]
    s_add_u32 s50, s47, 0x188000
    s_add_u32 m0, s49, 0x14400
    s_nop 0
    buffer_load_dwordx4 v207, s[32:35], s50 offen lds
    ds_read_b64_tr_b16 v[180:181], v101 offset:8192
    ds_read_b64_tr_b16 v[182:183], v101 offset:9216
    s_waitcnt lgkmcnt(12)
    v_mfma_f32_32x32x16_bf16 v[0:15], v[160:163], v[112:115], v[0:15]
    s_add_u32 s50, s48, 0x0
    s_add_u32 m0, s49, 0x0
    s_nop 0
    buffer_load_dwordx4 v204, s[24:27], s50 offen lds
    s_setprio 0
    ds_read_b128 v[124:127], v105
    ds_read_b64_tr_b16 v[184:185], v100 offset:12288
    ds_read_b64_tr_b16 v[186:187], v100 offset:13312
    s_waitcnt lgkmcnt(13)
    v_mfma_f32_32x32x16_bf16 v[16:31], v[164:167], v[112:115], v[16:31]
    s_add_u32 s50, s48, 0x0
    s_add_u32 m0, s49, 0x0
    s_nop 0
    buffer_load_dwordx4 v205, s[24:27], s50 offen offset:1024 lds
    ds_read_b64_tr_b16 v[188:189], v101 offset:12288
    ds_read_b64_tr_b16 v[190:191], v101 offset:13312
    s_waitcnt lgkmcnt(12)
    v_mfma_f32_32x32x16_bf16 v[0:15], v[168:171], v[116:119], v[0:15]
    s_add_u32 s50, s48, 0x10000
    s_add_u32 m0, s49, 0xc000
    s_nop 0
    buffer_load_dwordx4 v204, s[24:27], s50 offen lds
    s_setprio 3
    s_waitcnt vmcnt(9)
    s_waitcnt vmcnt(7)
    s_barrier
    v_add_u32 v100, 0x8000, v96
    v_add_u32 v101, 0x8000, v97
    v_xor_b32 v102, 0, v98
    v_add_u32 v102, 0x4000, v102
    v_xor_b32 v103, 32, v98
    v_add_u32 v103, 0x4000, v103
    v_xor_b32 v104, 64, v98
    v_add_u32 v104, 0x4000, v104
    v_xor_b32 v105, 96, v98
    v_add_u32 v105, 0x4000, v105
    ds_read_b128 v[112:115], v102
    ds_read_b64_tr_b16 v[160:161], v100 offset:0
    ds_read_b64_tr_b16 v[162:163], v100 offset:1024
    s_waitcnt lgkmcnt(13)
    v_mfma_f32_32x32x16_bf16 v[16:31], v[172:175], v[116:119], v[16:31]
    s_add_u32 s50, s48, 0x10000
    s_add_u32 m0, s49, 0xc000
    s_nop 0
    buffer_load_dwordx4 v205, s[24:27], s50 offen offset:1024 lds
    ds_read_b64_tr_b16 v[164:165], v101 offset:0
    ds_read_b64_tr_b16 v[166:167], v101 offset:1024
    s_waitcnt lgkmcnt(12)
    v_mfma_f32_32x32x16_bf16 v[0:15], v[176:179], v[120:123], v[0:15]
    s_add_u32 s50, s56, 512
    s_add_u32 m0, s49, 0x20000
    s_nop 0
    buffer_load_dwordx4 v208, s[20:23], s50 offen lds
    s_setprio 2
    ds_read_b128 v[116:119], v103
    ds_read_b64_tr_b16 v[168:169], v100 offset:4096
    ds_read_b64_tr_b16 v[170:171], v100 offset:5120
    s_waitcnt lgkmcnt(13)
    v_mfma_f32_32x32x16_bf16 v[16:31], v[180:183], v[120:123], v[16:31]
    s_add_u32 s50, s56, 512
    s_add_u32 m0, s49, 0x20400
    s_nop 0
    buffer_load_dwordx4 v209, s[20:23], s50 offen lds
    ds_read_b64_tr_b16 v[172:173], v101 offset:4096
    ds_read_b64_tr_b16 v[174:175], v101 offset:5120
    s_waitcnt lgkmcnt(12)
    v_mfma_f32_32x32x16_bf16 v[0:15], v[184:187], v[124:127], v[0:15]
    s_add_u32 s50, s47, 0x200000
    s_add_u32 m0, s49, 0x24000
    s_nop 0
    buffer_load_dwordx4 v207, s[32:35], s50 offen lds
    s_setprio 1
    ds_read_b128 v[120:123], v104
    ds_read_b64_tr_b16 v[176:177], v100 offset:8192
    ds_read_b64_tr_b16 v[178:179], v100 offset:9216
    s_waitcnt lgkmcnt(13)
    v_mfma_f32_32x32x16_bf16 v[16:31], v[188:191], v[124:127], v[16:31]
    s_add_u32 s50, s47, 0x208000
    s_add_u32 m0, s49, 0x24400
    s_nop 0
    buffer_load_dwordx4 v207, s[32:35], s50 offen lds
    ds_read_b64_tr_b16 v[180:181], v101 offset:8192
    ds_read_b64_tr_b16 v[182:183], v101 offset:9216
    s_waitcnt lgkmcnt(12)
    v_mfma_f32_32x32x16_bf16 v[0:15], v[160:163], v[112:115], v[0:15]
    s_setprio 0
    ds_read_b128 v[124:127], v105
    ds_read_b64_tr_b16 v[184:185], v100 offset:12288
    ds_read_b64_tr_b16 v[186:187], v100 offset:13312
    s_waitcnt lgkmcnt(13)
    v_mfma_f32_32x32x16_bf16 v[16:31], v[164:167], v[112:115], v[16:31]
    ds_read_b64_tr_b16 v[188:189], v101 offset:12288
    ds_read_b64_tr_b16 v[190:191], v101 offset:13312
    s_waitcnt lgkmcnt(12)
    v_mfma_f32_32x32x16_bf16 v[0:15], v[168:171], v[116:119], v[0:15]
    s_setprio 3
    s_waitcnt vmcnt(10)
    s_waitcnt vmcnt(8)
    s_barrier
    v_add_u32 v100, 0x14000, v96
    v_add_u32 v101, 0x14000, v97
    v_xor_b32 v102, 0, v98
    v_add_u32 v102, 0x10000, v102
    v_xor_b32 v103, 32, v98
    v_add_u32 v103, 0x10000, v103
    v_xor_b32 v104, 64, v98
    v_add_u32 v104, 0x10000, v104
    v_xor_b32 v105, 96, v98
    v_add_u32 v105, 0x10000, v105
    ds_read_b128 v[112:115], v102
    ds_read_b64_tr_b16 v[160:161], v100 offset:0
    ds_read_b64_tr_b16 v[162:163], v100 offset:1024
    s_waitcnt lgkmcnt(13)
    v_mfma_f32_32x32x16_bf16 v[16:31], v[172:175], v[116:119], v[16:31]
    s_add_u32 s50, s56, 640
    s_add_u32 m0, s49, 0x18000
    s_nop 0
    buffer_load_dwordx4 v208, s[20:23], s50 offen lds
    ds_read_b64_tr_b16 v[164:165], v101 offset:0
    ds_read_b64_tr_b16 v[166:167], v101 offset:1024
    s_waitcnt lgkmcnt(12)
    v_mfma_f32_32x32x16_bf16 v[0:15], v[176:179], v[120:123], v[0:15]
    s_add_u32 s50, s56, 640
    s_add_u32 m0, s49, 0x18400
    s_nop 0
    buffer_load_dwordx4 v209, s[20:23], s50 offen lds
    s_setprio 2
    ds_read_b128 v[116:119], v103
    ds_read_b64_tr_b16 v[168:169], v100 offset:4096
    ds_read_b64_tr_b16 v[170:171], v100 offset:5120
    s_waitcnt lgkmcnt(13)
    v_mfma_f32_32x32x16_bf16 v[16:31], v[180:183], v[120:123], v[16:31]
    s_add_u32 s50, s47, 0x280000
    s_add_u32 m0, s49, 0x1c000
    s_nop 0
    buffer_load_dwordx4 v207, s[32:35], s50 offen lds
    ds_read_b64_tr_b16 v[172:173], v101 offset:4096
    ds_read_b64_tr_b16 v[174:175], v101 offset:5120
    s_waitcnt lgkmcnt(12)
    v_mfma_f32_32x32x16_bf16 v[0:15], v[184:187], v[124:127], v[0:15]
    s_add_u32 s50, s47, 0x288000
    s_add_u32 m0, s49, 0x1c400
    s_nop 0
    buffer_load_dwordx4 v207, s[32:35], s50 offen lds
    s_setprio 1
    ds_read_b128 v[120:123], v104
    ds_read_b64_tr_b16 v[176:177], v100 offset:8192
    ds_read_b64_tr_b16 v[178:179], v100 offset:9216
    s_waitcnt lgkmcnt(13)
    v_mfma_f32_32x32x16_bf16 v[16:31], v[188:191], v[124:127], v[16:31]
    ds_read_b64_tr_b16 v[180:181], v101 offset:8192
    ds_read_b64_tr_b16 v[182:183], v101 offset:9216
    s_waitcnt lgkmcnt(12)
    v_mfma_f32_32x32x16_bf16 v[0:15], v[160:163], v[112:115], v[0:15]
    s_setprio 0
    ds_read_b128 v[124:127], v105
    ds_read_b64_tr_b16 v[184:185], v100 offset:12288
    ds_read_b64_tr_b16 v[186:187], v100 offset:13312
    s_waitcnt lgkmcnt(13)
    v_mfma_f32_32x32x16_bf16 v[16:31], v[164:167], v[112:115], v[16:31]
    ds_read_b64_tr_b16 v[188:189], v101 offset:12288
    ds_read_b64_tr_b16 v[190:191], v101 offset:13312
    s_waitcnt lgkmcnt(12)
    v_mfma_f32_32x32x16_bf16 v[0:15], v[168:171], v[116:119], v[0:15]
    s_setprio 3
    s_waitcnt vmcnt(6)
    s_waitcnt vmcnt(4)
    s_barrier
    v_add_u32 v100, 0x24000, v96
    v_add_u32 v101, 0x24000, v97
    v_xor_b32 v102, 0, v98
    v_add_u32 v102, 0x20000, v102
    v_xor_b32 v103, 32, v98
    v_add_u32 v103, 0x20000, v103
    v_xor_b32 v104, 64, v98
    v_add_u32 v104, 0x20000, v104
    v_xor_b32 v105, 96, v98
    v_add_u32 v105, 0x20000, v105
    ds_read_b128 v[112:115], v102
    ds_read_b64_tr_b16 v[160:161], v100 offset:0
    ds_read_b64_tr_b16 v[162:163], v100 offset:1024
    s_waitcnt lgkmcnt(13)
    v_mfma_f32_32x32x16_bf16 v[16:31], v[172:175], v[116:119], v[16:31]
    s_add_u32 s50, s56, 768
    s_add_u32 m0, s49, 0x4000
    s_nop 0
    buffer_load_dwordx4 v208, s[20:23], s50 offen lds
    ds_read_b64_tr_b16 v[164:165], v101 offset:0
    ds_read_b64_tr_b16 v[166:167], v101 offset:1024
    s_waitcnt lgkmcnt(12)
    v_mfma_f32_32x32x16_bf16 v[0:15], v[176:179], v[120:123], v[0:15]
    s_add_u32 s50, s56, 768
    s_add_u32 m0, s49, 0x4400
    s_nop 0
    buffer_load_dwordx4 v209, s[20:23], s50 offen lds
    s_setprio 2
    ds_read_b128 v[116:119], v103
    ds_read_b64_tr_b16 v[168:169], v100 offset:4096
    ds_read_b64_tr_b16 v[170:171], v100 offset:5120
    s_waitcnt lgkmcnt(13)
    v_mfma_f32_32x32x16_bf16 v[16:31], v[180:183], v[120:123], v[16:31]
    s_add_u32 s50, s47, 0x300000
    s_add_u32 m0, s49, 0x8000
    s_nop 0
    buffer_load_dwordx4 v207, s[32:35], s50 offen lds
    ds_read_b64_tr_b16 v[172:173], v101 offset:4096
    ds_read_b64_tr_b16 v[174:175], v101 offset:5120
    s_waitcnt lgkmcnt(12)
    v_mfma_f32_32x32x16_bf16 v[0:15], v[184:187], v[124:127], v[0:15]
    s_add_u32 s50, s47, 0x308000
    s_add_u32 m0, s49, 0x8400
    s_nop 0
    buffer_load_dwordx4 v207, s[32:35], s50 offen lds
    s_setprio 1
    ds_read_b128 v[120:123], v104
    ds_read_b64_tr_b16 v[176:177], v100 offset:8192
    ds_read_b64_tr_b16 v[178:179], v100 offset:9216
    s_waitcnt lgkmcnt(13)
    v_mfma_f32_32x32x16_bf16 v[16:31], v[188:191], v[124:127], v[16:31]
    ds_read_b64_tr_b16 v[180:181], v101 offset:8192
    ds_read_b64_tr_b16 v[182:183], v101 offset:9216
    s_waitcnt lgkmcnt(12)
    v_mfma_f32_32x32x16_bf16 v[0:15], v[160:163], v[112:115], v[0:15]
    s_setprio 0
    ds_read_b128 v[124:127], v105
    ds_read_b64_tr_b16 v[184:185], v100 offset:12288
    ds_read_b64_tr_b16 v[186:187], v100 offset:13312
    s_waitcnt lgkmcnt(13)
    v_mfma_f32_32x32x16_bf16 v[16:31], v[164:167], v[112:115], v[16:31]
    ds_read_b64_tr_b16 v[188:189], v101 offset:12288
    ds_read_b64_tr_b16 v[190:191], v101 offset:13312
    s_waitcnt lgkmcnt(12)
    v_mfma_f32_32x32x16_bf16 v[0:15], v[168:171], v[116:119], v[0:15]
    s_setprio 3
    s_waitcnt vmcnt(6)
    s_waitcnt vmcnt(4)
    s_barrier
    v_add_u32 v100, 0x1c000, v96
    v_add_u32 v101, 0x1c000, v97
    v_xor_b32 v102, 0, v98
    v_add_u32 v102, 0x18000, v102
    v_xor_b32 v103, 32, v98
    v_add_u32 v103, 0x18000, v103
    v_xor_b32 v104, 64, v98
    v_add_u32 v104, 0x18000, v104
    v_xor_b32 v105, 96, v98
    v_add_u32 v105, 0x18000, v105
    ds_read_b128 v[112:115], v102
    ds_read_b64_tr_b16 v[160:161], v100 offset:0
    ds_read_b64_tr_b16 v[162:163], v100 offset:1024
    s_waitcnt lgkmcnt(13)
    v_mfma_f32_32x32x16_bf16 v[16:31], v[172:175], v[116:119], v[16:31]
    s_add_u32 s50, s56, 896
    s_add_u32 m0, s49, 0x10000
    s_nop 0
    buffer_load_dwordx4 v208, s[20:23], s50 offen lds
    ds_read_b64_tr_b16 v[164:165], v101 offset:0
    ds_read_b64_tr_b16 v[166:167], v101 offset:1024
    s_waitcnt lgkmcnt(12)
    v_mfma_f32_32x32x16_bf16 v[0:15], v[176:179], v[120:123], v[0:15]
    s_add_u32 s50, s56, 896
    s_add_u32 m0, s49, 0x10400
    s_nop 0
    buffer_load_dwordx4 v209, s[20:23], s50 offen lds
    s_setprio 2
    ds_read_b128 v[116:119], v103
    ds_read_b64_tr_b16 v[168:169], v100 offset:4096
    ds_read_b64_tr_b16 v[170:171], v100 offset:5120
    s_waitcnt lgkmcnt(13)
    v_mfma_f32_32x32x16_bf16 v[16:31], v[180:183], v[120:123], v[16:31]
    s_add_u32 s50, s47, 0x380000
    s_add_u32 m0, s49, 0x14000
    s_nop 0
    buffer_load_dwordx4 v207, s[32:35], s50 offen lds
    ds_read_b64_tr_b16 v[172:173], v101 offset:4096
    ds_read_b64_tr_b16 v[174:175], v101 offset:5120
    s_waitcnt lgkmcnt(12)
    v_mfma_f32_32x32x16_bf16 v[0:15], v[184:187], v[124:127], v[0:15]
    s_add_u32 s50, s47, 0x388000
    s_add_u32 m0, s49, 0x14400
    s_nop 0
    buffer_load_dwordx4 v207, s[32:35], s50 offen lds
    s_setprio 1
    ds_read_b128 v[120:123], v104
    ds_read_b64_tr_b16 v[176:177], v100 offset:8192
    ds_read_b64_tr_b16 v[178:179], v100 offset:9216
    s_waitcnt lgkmcnt(13)
    v_mfma_f32_32x32x16_bf16 v[16:31], v[188:191], v[124:127], v[16:31]
    ds_read_b64_tr_b16 v[180:181], v101 offset:8192
    ds_read_b64_tr_b16 v[182:183], v101 offset:9216
    s_waitcnt lgkmcnt(12)
    v_mfma_f32_32x32x16_bf16 v[0:15], v[160:163], v[112:115], v[0:15]
    s_setprio 0
    ds_read_b128 v[124:127], v105
    ds_read_b64_tr_b16 v[184:185], v100 offset:12288
    ds_read_b64_tr_b16 v[186:187], v100 offset:13312
    s_waitcnt lgkmcnt(13)
    v_mfma_f32_32x32x16_bf16 v[16:31], v[164:167], v[112:115], v[16:31]
    ds_read_b64_tr_b16 v[188:189], v101 offset:12288
    ds_read_b64_tr_b16 v[190:191], v101 offset:13312
    s_waitcnt lgkmcnt(12)
    v_mfma_f32_32x32x16_bf16 v[0:15], v[168:171], v[116:119], v[0:15]
    s_setprio 3
    s_waitcnt vmcnt(6)
    s_waitcnt vmcnt(4)
    s_barrier
    v_add_u32 v100, 0x8000, v96
    v_add_u32 v101, 0x8000, v97
    v_xor_b32 v102, 0, v98
    v_add_u32 v102, 0x4000, v102
    v_xor_b32 v103, 32, v98
    v_add_u32 v103, 0x4000, v103
    v_xor_b32 v104, 64, v98
    v_add_u32 v104, 0x4000, v104
    v_xor_b32 v105, 96, v98
    v_add_u32 v105, 0x4000, v105
    ds_read_b128 v[112:115], v102
    ds_read_b64_tr_b16 v[160:161], v100 offset:0
    ds_read_b64_tr_b16 v[162:163], v100 offset:1024
    s_waitcnt lgkmcnt(13)
    v_mfma_f32_32x32x16_bf16 v[16:31], v[172:175], v[116:119], v[16:31]
    s_add_u32 s50, s56, 1024
    s_add_u32 m0, s49, 0x20000
    s_nop 0
    buffer_load_dwordx4 v208, s[20:23], s50 offen lds
    ds_read_b64_tr_b16 v[164:165], v101 offset:0
    ds_read_b64_tr_b16 v[166:167], v101 offset:1024
    s_waitcnt lgkmcnt(12)
    v_mfma_f32_32x32x16_bf16 v[0:15], v[176:179], v[120:123], v[0:15]
    s_add_u32 s50, s56, 1024
    s_add_u32 m0, s49, 0x20400
    s_nop 0
    buffer_load_dwordx4 v209, s[20:23], s50 offen lds
    s_setprio 2
    ds_read_b128 v[116:119], v103
    ds_read_b64_tr_b16 v[168:169], v100 offset:4096
    ds_read_b64_tr_b16 v[170:171], v100 offset:5120
    s_waitcnt lgkmcnt(13)
    v_mfma_f32_32x32x16_bf16 v[16:31], v[180:183], v[120:123], v[16:31]
    s_add_u32 s50, s47, 0x400000
    s_add_u32 m0, s49, 0x24000
    s_nop 0
    buffer_load_dwordx4 v207, s[32:35], s50 offen lds
    ds_read_b64_tr_b16 v[172:173], v101 offset:4096
    ds_read_b64_tr_b16 v[174:175], v101 offset:5120
    s_waitcnt lgkmcnt(12)
    v_mfma_f32_32x32x16_bf16 v[0:15], v[184:187], v[124:127], v[0:15]
    s_add_u32 s50, s47, 0x408000
    s_add_u32 m0, s49, 0x24400
    s_nop 0
    buffer_load_dwordx4 v207, s[32:35], s50 offen lds
    s_setprio 1
    ds_read_b128 v[120:123], v104
    ds_read_b64_tr_b16 v[176:177], v100 offset:8192
    ds_read_b64_tr_b16 v[178:179], v100 offset:9216
    s_waitcnt lgkmcnt(13)
    v_mfma_f32_32x32x16_bf16 v[16:31], v[188:191], v[124:127], v[16:31]
    ds_read_b64_tr_b16 v[180:181], v101 offset:8192
    ds_read_b64_tr_b16 v[182:183], v101 offset:9216
    s_waitcnt lgkmcnt(12)
    v_mfma_f32_32x32x16_bf16 v[0:15], v[160:163], v[112:115], v[0:15]
    s_setprio 0
    ds_read_b128 v[124:127], v105
    ds_read_b64_tr_b16 v[184:185], v100 offset:12288
    ds_read_b64_tr_b16 v[186:187], v100 offset:13312
    s_waitcnt lgkmcnt(13)
    v_mfma_f32_32x32x16_bf16 v[16:31], v[164:167], v[112:115], v[16:31]
    ds_read_b64_tr_b16 v[188:189], v101 offset:12288
    ds_read_b64_tr_b16 v[190:191], v101 offset:13312
    s_waitcnt lgkmcnt(12)
    v_mfma_f32_32x32x16_bf16 v[0:15], v[168:171], v[116:119], v[0:15]
    s_setprio 3
    s_waitcnt vmcnt(6)
    s_waitcnt vmcnt(4)
    s_barrier
    v_add_u32 v100, 0x14000, v96
    v_add_u32 v101, 0x14000, v97
    v_xor_b32 v102, 0, v98
    v_add_u32 v102, 0x10000, v102
    v_xor_b32 v103, 32, v98
    v_add_u32 v103, 0x10000, v103
    v_xor_b32 v104, 64, v98
    v_add_u32 v104, 0x10000, v104
    v_xor_b32 v105, 96, v98
    v_add_u32 v105, 0x10000, v105
    ds_read_b128 v[112:115], v102
    ds_read_b64_tr_b16 v[160:161], v100 offset:0
    ds_read_b64_tr_b16 v[162:163], v100 offset:1024
    s_waitcnt lgkmcnt(13)
    v_mfma_f32_32x32x16_bf16 v[16:31], v[172:175], v[116:119], v[16:31]
    s_add_u32 s50, s48, 0x0
    s_add_u32 m0, s49, 0x18000
    s_nop 0
    buffer_load_dwordx4 v206, s[28:31], s50 offen lds
    ds_read_b64_tr_b16 v[164:165], v101 offset:0
    ds_read_b64_tr_b16 v[166:167], v101 offset:1024
    s_waitcnt lgkmcnt(12)
    v_mfma_f32_32x32x16_bf16 v[0:15], v[176:179], v[120:123], v[0:15]
    s_add_u32 s50, s48, 0x0
    s_add_u32 m0, s49, 0x18000
    s_nop 0
    buffer_load_dwordx4 v206, s[28:31], s50 offen offset:1024 lds
    s_setprio 2
    ds_read_b128 v[116:119], v103
    ds_read_b64_tr_b16 v[168:169], v100 offset:4096
    ds_read_b64_tr_b16 v[170:171], v100 offset:5120
    s_waitcnt lgkmcnt(13)
    v_mfma_f32_32x32x16_bf16 v[16:31], v[180:183], v[120:123], v[16:31]
    s_add_u32 s50, s48, 0x4000
    s_add_u32 m0, s49, 0x1c000
    s_nop 0
    buffer_load_dwordx4 v206, s[28:31], s50 offen lds
    ds_read_b64_tr_b16 v[172:173], v101 offset:4096
    ds_read_b64_tr_b16 v[174:175], v101 offset:5120
    s_waitcnt lgkmcnt(12)
    v_mfma_f32_32x32x16_bf16 v[0:15], v[184:187], v[124:127], v[0:15]
    s_add_u32 s50, s48, 0x4000
    s_add_u32 m0, s49, 0x1c000
    s_nop 0
    buffer_load_dwordx4 v206, s[28:31], s50 offen offset:1024 lds
    s_setprio 1
    ds_read_b128 v[120:123], v104
    ds_read_b64_tr_b16 v[176:177], v100 offset:8192
    ds_read_b64_tr_b16 v[178:179], v100 offset:9216
    s_waitcnt lgkmcnt(13)
    v_mfma_f32_32x32x16_bf16 v[16:31], v[188:191], v[124:127], v[16:31]
    ds_read_b64_tr_b16 v[180:181], v101 offset:8192
    ds_read_b64_tr_b16 v[182:183], v101 offset:9216
    s_waitcnt lgkmcnt(12)
    v_mfma_f32_32x32x16_bf16 v[0:15], v[160:163], v[112:115], v[0:15]
    s_setprio 0
    ds_read_b128 v[124:127], v105
    ds_read_b64_tr_b16 v[184:185], v100 offset:12288
    ds_read_b64_tr_b16 v[186:187], v100 offset:13312
    s_waitcnt lgkmcnt(13)
    v_mfma_f32_32x32x16_bf16 v[16:31], v[164:167], v[112:115], v[16:31]
    ds_read_b64_tr_b16 v[188:189], v101 offset:12288
    ds_read_b64_tr_b16 v[190:191], v101 offset:13312
    s_waitcnt lgkmcnt(12)
    v_mfma_f32_32x32x16_bf16 v[0:15], v[168:171], v[116:119], v[0:15]
    s_setprio 3
    s_waitcnt vmcnt(6)
    s_waitcnt vmcnt(4)
    s_barrier
    v_add_u32 v100, 0x24000, v96
    v_add_u32 v101, 0x24000, v97
    v_xor_b32 v102, 0, v98
    v_add_u32 v102, 0x20000, v102
    v_xor_b32 v103, 32, v98
    v_add_u32 v103, 0x20000, v103
    v_xor_b32 v104, 64, v98
    v_add_u32 v104, 0x20000, v104
    v_xor_b32 v105, 96, v98
    v_add_u32 v105, 0x20000, v105
    ds_read_b128 v[112:115], v102
    ds_read_b64_tr_b16 v[160:161], v100 offset:0
    ds_read_b64_tr_b16 v[162:163], v100 offset:1024
    s_waitcnt lgkmcnt(13)
    v_mfma_f32_32x32x16_bf16 v[16:31], v[172:175], v[116:119], v[16:31]
    s_add_u32 s50, s48, 0x4000
    s_add_u32 m0, s49, 0x4000
    s_nop 0
    buffer_load_dwordx4 v204, s[24:27], s50 offen lds
    ds_read_b64_tr_b16 v[164:165], v101 offset:0
    ds_read_b64_tr_b16 v[166:167], v101 offset:1024
    s_waitcnt lgkmcnt(12)
    v_mfma_f32_32x32x16_bf16 v[0:15], v[176:179], v[120:123], v[0:15]
    s_add_u32 s50, s48, 0x4000
    s_add_u32 m0, s49, 0x4000
    s_nop 0
    buffer_load_dwordx4 v205, s[24:27], s50 offen offset:1024 lds
    ds_read_b128 v[116:119], v103
    ds_read_b64_tr_b16 v[168:169], v100 offset:4096
    ds_read_b64_tr_b16 v[170:171], v100 offset:5120
    s_waitcnt lgkmcnt(13)
    v_mfma_f32_32x32x16_bf16 v[16:31], v[180:183], v[120:123], v[16:31]
    s_add_u32 s50, s48, 0x8000
    s_add_u32 m0, s49, 0x8000
    s_nop 0
    buffer_load_dwordx4 v204, s[24:27], s50 offen lds
    ds_read_b64_tr_b16 v[172:173], v101 offset:4096
    ds_read_b64_tr_b16 v[174:175], v101 offset:5120
    s_waitcnt lgkmcnt(12)
    v_mfma_f32_32x32x16_bf16 v[0:15], v[184:187], v[124:127], v[0:15]
    s_add_u32 s50, s48, 0x8000
    s_add_u32 m0, s49, 0x8000
    s_nop 0
    buffer_load_dwordx4 v205, s[24:27], s50 offen offset:1024 lds
    s_setprio 2
    ds_read_b128 v[120:123], v104
    ds_read_b64_tr_b16 v[176:177], v100 offset:8192
    ds_read_b64_tr_b16 v[178:179], v100 offset:9216
    s_waitcnt lgkmcnt(13)
    v_mfma_f32_32x32x16_bf16 v[16:31], v[188:191], v[124:127], v[16:31]
    ds_read_b64_tr_b16 v[180:181], v101 offset:8192
    ds_read_b64_tr_b16 v[182:183], v101 offset:9216
    s_waitcnt lgkmcnt(12)
    v_mfma_f32_32x32x16_bf16 v[0:15], v[160:163], v[112:115], v[0:15]
    ds_read_b128 v[124:127], v105
    ds_read_b64_tr_b16 v[184:185], v100 offset:12288
    ds_read_b64_tr_b16 v[186:187], v100 offset:13312
    s_waitcnt lgkmcnt(13)
    v_mfma_f32_32x32x16_bf16 v[16:31], v[164:167], v[112:115], v[16:31]
    s_setprio 1
    ds_read_b64_tr_b16 v[188:189], v101 offset:12288
    ds_read_b64_tr_b16 v[190:191], v101 offset:13312
    s_waitcnt lgkmcnt(12)
    v_mfma_f32_32x32x16_bf16 v[0:15], v[168:171], v[116:119], v[0:15]
    s_waitcnt lgkmcnt(10)
    v_mfma_f32_32x32x16_bf16 v[16:31], v[172:175], v[116:119], v[16:31]
    s_waitcnt lgkmcnt(7)
    v_mfma_f32_32x32x16_bf16 v[0:15], v[176:179], v[120:123], v[0:15]
    s_setprio 0
    s_waitcnt lgkmcnt(5)
    v_mfma_f32_32x32x16_bf16 v[16:31], v[180:183], v[120:123], v[16:31]
    s_waitcnt lgkmcnt(2)
    v_mfma_f32_32x32x16_bf16 v[0:15], v[184:187], v[124:127], v[0:15]
    s_waitcnt lgkmcnt(0)
    v_mfma_f32_32x32x16_bf16 v[16:31], v[188:191], v[124:127], v[16:31]
    s_nop 9
    v_cvt_pk_bf16_f32 v160, v0, v1
    v_cvt_pk_bf16_f32 v161, v2, v3
    v_cvt_pk_bf16_f32 v162, v4, v5
    v_cvt_pk_bf16_f32 v163, v6, v7
    v_cvt_pk_bf16_f32 v164, v8, v9
    v_cvt_pk_bf16_f32 v165, v10, v11
    v_cvt_pk_bf16_f32 v166, v12, v13
    v_cvt_pk_bf16_f32 v167, v14, v15
    v_cvt_pk_bf16_f32 v168, v16, v17
    v_cvt_pk_bf16_f32 v169, v18, v19
    v_cvt_pk_bf16_f32 v170, v20, v21
    v_cvt_pk_bf16_f32 v171, v22, v23
    v_cvt_pk_bf16_f32 v172, v24, v25
    v_cvt_pk_bf16_f32 v173, v26, v27
    v_cvt_pk_bf16_f32 v174, v28, v29
    v_cvt_pk_bf16_f32 v175, v30, v31
    s_barrier
    s_lshr_b32 s52, s57, 1
    s_mul_i32 s52, s52, 16384
    s_and_b32 s53, s57, 1
    s_lshl_b32 s53, s53, 13
    s_add_u32 s52, s52, s53
    s_add_u32 s52, s52, 131072
    s_lshl_b32 s53, s58, 12
    s_add_u32 s54, s52, s53
    v_add_u32 v220, s54, v218
    v_add_u32 v221, s52, v218
    ds_write_b128 v220, v[160:163] offset:0
    ds_write_b128 v220, v[164:167] offset:1024
    ds_write_b128 v220, v[168:171] offset:2048
    ds_write_b128 v220, v[172:175] offset:3072
    s_waitcnt lgkmcnt(0)
    s_barrier
    ds_read_b128 v[64:67], v221 offset:0
    ds_read_b128 v[68:71], v221 offset:1024
    ds_read_b128 v[72:75], v221 offset:2048
    ds_read_b128 v[76:79], v221 offset:3072
    ds_read_b128 v[80:83], v221 offset:4096
    ds_read_b128 v[84:87], v221 offset:5120
    ds_read_b128 v[88:91], v221 offset:6144
    ds_read_b128 v[92:95], v221 offset:7168
    s_barrier
    ds_read_b128 v[160:163], v192 offset:0
    ds_read_b128 v[164:167], v193 offset:0
    ds_read_b128 v[168:171], v194 offset:0
    ds_read_b128 v[172:175], v195 offset:0
    ds_read_b128 v[176:179], v196 offset:0
    s_setprio 3
    ds_read_b128 v[180:183], v197 offset:0
    s_waitcnt lgkmcnt(5)
    v_mfma_f32_32x32x16_bf16 v[96:111], v[160:163], v[64:67], 0
    s_add_u32 s50, s48, 0x14000
    s_add_u32 m0, s49, 0x10000
    s_nop 0
    buffer_load_dwordx4 v204, s[24:27], s50 offen lds
    ds_read_b128 v[184:187], v198 offset:0
    s_waitcnt lgkmcnt(5)
    v_mfma_f32_32x32x16_bf16 v[96:111], v[164:167], v[68:71], v[96:111]
    s_add_u32 s50, s48, 0x14000
    s_add_u32 m0, s49, 0x10000
    s_nop 0
    buffer_load_dwordx4 v205, s[24:27], s50 offen offset:1024 lds
    ds_read_b128 v[188:191], v199 offset:0
    s_waitcnt lgkmcnt(5)
    v_mfma_f32_32x32x16_bf16 v[96:111], v[168:171], v[72:75], v[96:111]
    s_add_u32 s50, s48, 0x18000
    s_add_u32 m0, s49, 0x14000
    s_nop 0
    buffer_load_dwordx4 v204, s[24:27], s50 offen lds
    s_setprio 2
    ds_read_b128 v[160:163], v192 offset:8192
    s_waitcnt lgkmcnt(5)
    v_mfma_f32_32x32x16_bf16 v[96:111], v[172:175], v[76:79], v[96:111]
    s_add_u32 s50, s48, 0x18000
    s_add_u32 m0, s49, 0x14000
    s_nop 0
    buffer_load_dwordx4 v205, s[24:27], s50 offen offset:1024 lds
    ds_read_b128 v[164:167], v193 offset:8192
    s_waitcnt lgkmcnt(5)
    v_mfma_f32_32x32x16_bf16 v[96:111], v[176:179], v[80:83], v[96:111]
    ds_read_b128 v[168:171], v194 offset:8192
    s_waitcnt lgkmcnt(5)
    v_mfma_f32_32x32x16_bf16 v[96:111], v[180:183], v[84:87], v[96:111]
    s_setprio 1
    ds_read_b128 v[172:175], v195 offset:8192
    s_waitcnt lgkmcnt(5)
    v_mfma_f32_32x32x16_bf16 v[96:111], v[184:187], v[88:91], v[96:111]
    ds_read_b128 v[176:179], v196 offset:8192
    s_waitcnt lgkmcnt(5)
    v_mfma_f32_32x32x16_bf16 v[96:111], v[188:191], v[92:95], v[96:111]
    ds_read_b128 v[180:183], v197 offset:8192
    s_waitcnt lgkmcnt(5)
    v_mfma_f32_32x32x16_bf16 v[112:127], v[160:163], v[64:67], 0
    s_setprio 0
    ds_read_b128 v[184:187], v198 offset:8192
    s_waitcnt lgkmcnt(5)
    v_mfma_f32_32x32x16_bf16 v[112:127], v[164:167], v[68:71], v[112:127]
    ds_read_b128 v[188:191], v199 offset:8192
    s_waitcnt lgkmcnt(5)
    v_mfma_f32_32x32x16_bf16 v[112:127], v[168:171], v[72:75], v[112:127]
    s_setprio 3
    s_waitcnt vmcnt(6)
    s_waitcnt vmcnt(2)
    s_barrier
    ds_read_b128 v[160:163], v192 offset:16384
    s_waitcnt lgkmcnt(5)
    v_mfma_f32_32x32x16_bf16 v[112:127], v[172:175], v[76:79], v[112:127]
    v_max3_f32 v216, v96, v97, v98
    v_max3_f32 v216, v216, v99, v100
    s_add_u32 s50, s48, 0x10000
    s_add_u32 m0, s49, 0x20000
    s_nop 0
    buffer_load_dwordx4 v206, s[28:31], s50 offen lds
    ds_read_b128 v[164:167], v193 offset:16384
    s_waitcnt lgkmcnt(5)
    v_mfma_f32_32x32x16_bf16 v[112:127], v[176:179], v[80:83], v[112:127]
    v_max3_f32 v216, v216, v101, v102
    v_max3_f32 v216, v216, v103, v104
    s_add_u32 s50, s48, 0x10000
    s_add_u32 m0, s49, 0x20000
    s_nop 0
    buffer_load_dwordx4 v206, s[28:31], s50 offen offset:1024 lds
    ds_read_b128 v[168:171], v194 offset:16384
    s_waitcnt lgkmcnt(5)
    v_mfma_f32_32x32x16_bf16 v[112:127], v[180:183], v[84:87], v[112:127]
    v_max3_f32 v216, v216, v105, v106
    s_add_u32 s50, s48, 0x14000
    s_add_u32 m0, s49, 0x24000
    s_nop 0
    buffer_load_dwordx4 v206, s[28:31], s50 offen lds
    ds_read_b128 v[172:175], v195 offset:16384
    s_waitcnt lgkmcnt(5)
    v_mfma_f32_32x32x16_bf16 v[112:127], v[184:187], v[88:91], v[112:127]
    v_max3_f32 v216, v216, v107, v108
    v_max3_f32 v216, v216, v109, v110
    s_add_u32 s50, s48, 0x14000
    s_add_u32 m0, s49, 0x24000
    s_nop 0
    buffer_load_dwordx4 v206, s[28:31], s50 offen offset:1024 lds
    s_setprio 2
    ds_read_b128 v[176:179], v196 offset:16384
    s_waitcnt lgkmcnt(5)
    v_mfma_f32_32x32x16_bf16 v[112:127], v[188:191], v[92:95], v[112:127]
    v_max_f32 v216, v216, v111
    ds_read_b128 v[180:183], v197 offset:16384
    s_waitcnt lgkmcnt(5)
    v_mfma_f32_32x32x16_bf16 v[128:143], v[160:163], v[64:67], 0
    s_nop 7
    v_max3_f32 v217, v112, v113, v114
    v_max3_f32 v217, v217, v115, v116
    v_max3_f32 v217, v217, v117, v118
    v_max3_f32 v217, v217, v119, v120
    v_max3_f32 v217, v217, v121, v122
    ds_read_b128 v[184:187], v198 offset:16384
    s_waitcnt lgkmcnt(5)
    v_mfma_f32_32x32x16_bf16 v[128:143], v[164:167], v[68:71], v[128:143]
    v_max3_f32 v217, v217, v123, v124
    v_max3_f32 v217, v217, v125, v126
    v_max_f32 v217, v217, v127
    v_max_f32 v216, v216, v217
    v_mov_b32 v217, v216
    ds_read_b128 v[188:191], v199 offset:16384
    s_waitcnt lgkmcnt(5)
    v_mfma_f32_32x32x16_bf16 v[128:143], v[168:171], v[72:75], v[128:143]
    v_permlane32_swap_b32 v216, v217
    v_max_f32 v216, v216, v217
    v_mov_b32 v211, v216
    v_mul_f32 v212, s51, v216
    v_add_f32 v213, 0x427af233, v216
    v_mov_b32 v214, 0
    v_mov_b32 v215, 0
    v_fma_f32 v96, v96, s51, -v212
    s_setprio 1
    ds_read_b128 v[160:163], v192 offset:24576
    s_waitcnt lgkmcnt(5)
    v_mfma_f32_32x32x16_bf16 v[128:143], v[172:175], v[76:79], v[128:143]
    v_fma_f32 v97, v97, s51, -v212
    v_fma_f32 v98, v98, s51, -v212
    v_fma_f32 v99, v99, s51, -v212
    v_fma_f32 v100, v100, s51, -v212
    v_fma_f32 v101, v101, s51, -v212
    ds_read_b128 v[164:167], v193 offset:24576
    s_waitcnt lgkmcnt(5)
    v_mfma_f32_32x32x16_bf16 v[128:143], v[176:179], v[80:83], v[128:143]
    v_fma_f32 v102, v102, s51, -v212
    v_fma_f32 v103, v103, s51, -v212
    v_exp_f32 v96, v96
    v_exp_f32 v97, v97
    v_exp_f32 v98, v98
    ds_read_b128 v[168:171], v194 offset:24576
    s_waitcnt lgkmcnt(5)
    v_mfma_f32_32x32x16_bf16 v[128:143], v[180:183], v[84:87], v[128:143]
    v_exp_f32 v99, v99
    v_exp_f32 v100, v100
    v_exp_f32 v101, v101
    v_exp_f32 v102, v102
    ds_read_b128 v[172:175], v195 offset:24576
    s_waitcnt lgkmcnt(5)
    v_mfma_f32_32x32x16_bf16 v[128:143], v[184:187], v[88:91], v[128:143]
    v_exp_f32 v103, v103
    v_add_f32 v214, v214, v96
    v_add_f32 v215, v215, v97
    v_add_f32 v214, v214, v98
    v_add_f32 v215, v215, v99
    s_setprio 0
    ds_read_b128 v[176:179], v196 offset:24576
    s_waitcnt lgkmcnt(5)
    v_mfma_f32_32x32x16_bf16 v[128:143], v[188:191], v[92:95], v[128:143]
    v_add_f32 v214, v214, v100
    v_add_f32 v215, v215, v101
    v_add_f32 v214, v214, v102
    v_add_f32 v215, v215, v103
    v_cvt_pk_bf16_f32 v96, v96, v97
    ds_read_b128 v[180:183], v197 offset:24576
    s_waitcnt lgkmcnt(5)
    v_mfma_f32_32x32x16_bf16 v[144:159], v[160:163], v[64:67], 0
    v_cvt_pk_bf16_f32 v97, v98, v99
    v_cvt_pk_bf16_f32 v98, v100, v101
    v_cvt_pk_bf16_f32 v99, v102, v103
    v_fma_f32 v104, v104, s51, -v212
    ds_read_b128 v[184:187], v198 offset:24576
    s_waitcnt lgkmcnt(5)
    v_mfma_f32_32x32x16_bf16 v[144:159], v[164:167], v[68:71], v[144:159]
    v_fma_f32 v105, v105, s51, -v212
    v_fma_f32 v106, v106, s51, -v212
    v_fma_f32 v107, v107, s51, -v212
    v_fma_f32 v108, v108, s51, -v212
    v_fma_f32 v109, v109, s51, -v212
    ds_read_b128 v[188:191], v199 offset:24576
    s_waitcnt lgkmcnt(5)
    v_mfma_f32_32x32x16_bf16 v[144:159], v[168:171], v[72:75], v[144:159]
    v_fma_f32 v110, v110, s51, -v212
    v_fma_f32 v111, v111, s51, -v212
    v_exp_f32 v104, v104
    v_exp_f32 v105, v105
    s_setprio 3
    s_waitcnt vmcnt(2)
    s_barrier
    ds_read_b64_tr_b16 v[160:161], v200 offset:0
    ds_read_b64_tr_b16 v[162:163], v200 offset:2048
    s_waitcnt lgkmcnt(6)
    v_mfma_f32_32x32x16_bf16 v[144:159], v[172:175], v[76:79], v[144:159]
    v_exp_f32 v106, v106
    v_exp_f32 v107, v107
    v_exp_f32 v108, v108
    v_exp_f32 v109, v109
    v_exp_f32 v110, v110
    s_add_u32 s50, s48, 0xc000
    s_add_u32 m0, s49, 0x0
    s_nop 0
    buffer_load_dwordx4 v204, s[24:27], s50 offen lds
    ds_read_b64_tr_b16 v[164:165], v201 offset:0
    ds_read_b64_tr_b16 v[166:167], v201 offset:2048
    s_waitcnt lgkmcnt(7)
    v_mfma_f32_32x32x16_bf16 v[144:159], v[176:179], v[80:83], v[144:159]
    v_exp_f32 v111, v111
    v_add_f32 v214, v214, v104
    v_add_f32 v215, v215, v105
    v_add_f32 v214, v214, v106
    v_add_f32 v215, v215, v107
    s_add_u32 s50, s48, 0xc000
    s_add_u32 m0, s49, 0x0
    s_nop 0
    buffer_load_dwordx4 v205, s[24:27], s50 offen offset:1024 lds
    ds_read_b64_tr_b16 v[168:169], v202 offset:0
    ds_read_b64_tr_b16 v[170:171], v202 offset:2048
    s_waitcnt lgkmcnt(8)
    v_mfma_f32_32x32x16_bf16 v[144:159], v[180:183], v[84:87], v[144:159]
    v_add_f32 v214, v214, v108
    v_add_f32 v215, v215, v109
    v_add_f32 v214, v214, v110
    v_add_f32 v215, v215, v111
    s_add_u32 s50, s48, 0x1c000
    s_add_u32 m0, s49, 0xc000
    s_nop 0
    buffer_load_dwordx4 v204, s[24:27], s50 offen lds
    ds_read_b64_tr_b16 v[172:173], v203 offset:0
    ds_read_b64_tr_b16 v[174:175], v203 offset:2048
    s_waitcnt lgkmcnt(9)
    v_mfma_f32_32x32x16_bf16 v[144:159], v[184:187], v[88:91], v[144:159]
    v_cvt_pk_bf16_f32 v104, v104, v105
    v_cvt_pk_bf16_f32 v105, v106, v107
    v_cvt_pk_bf16_f32 v106, v108, v109
    v_cvt_pk_bf16_f32 v107, v110, v111
    v_fma_f32 v112, v112, s51, -v212
    s_add_u32 s50, s48, 0x1c000
    s_add_u32 m0, s49, 0xc000
    s_nop 0
    buffer_load_dwordx4 v205, s[24:27], s50 offen offset:1024 lds
    s_setprio 2
    ds_read_b64_tr_b16 v[176:177], v200 offset:4096
    ds_read_b64_tr_b16 v[178:179], v200 offset:6144
    s_waitcnt lgkmcnt(10)
    v_mfma_f32_32x32x16_bf16 v[144:159], v[188:191], v[92:95], v[144:159]
    v_fma_f32 v113, v113, s51, -v212
    v_fma_f32 v114, v114, s51, -v212
    v_fma_f32 v115, v115, s51, -v212
    v_fma_f32 v116, v116, s51, -v212
    v_fma_f32 v117, v117, s51, -v212
    ds_read_b64_tr_b16 v[180:181], v201 offset:4096
    ds_read_b64_tr_b16 v[182:183], v201 offset:6144
    s_waitcnt lgkmcnt(10)
    v_mfma_f32_32x32x16_bf16 v[0:15], v[160:163], v[96:99], 0
    v_fma_f32 v118, v118, s51, -v212
    v_fma_f32 v119, v119, s51, -v212
    v_exp_f32 v112, v112
    v_exp_f32 v113, v113
    ds_read_b64_tr_b16 v[184:185], v202 offset:4096
    ds_read_b64_tr_b16 v[186:187], v202 offset:6144
    s_waitcnt lgkmcnt(10)
    v_mfma_f32_32x32x16_bf16 v[16:31], v[164:167], v[96:99], 0
    v_exp_f32 v114, v114
    v_exp_f32 v115, v115
    v_exp_f32 v116, v116
    v_exp_f32 v117, v117
    v_exp_f32 v118, v118
    ds_read_b64_tr_b16 v[188:189], v203 offset:4096
    ds_read_b64_tr_b16 v[190:191], v203 offset:6144
    s_waitcnt lgkmcnt(10)
    v_mfma_f32_32x32x16_bf16 v[32:47], v[168:171], v[96:99], 0
    v_exp_f32 v119, v119
    v_add_f32 v214, v214, v112
    v_add_f32 v215, v215, v113
    v_add_f32 v214, v214, v114
    s_setprio 1
    ds_read_b64_tr_b16 v[160:161], v200 offset:8192
    ds_read_b64_tr_b16 v[162:163], v200 offset:10240
    s_waitcnt lgkmcnt(10)
    v_mfma_f32_32x32x16_bf16 v[48:63], v[172:175], v[96:99], 0
    v_add_f32 v215, v215, v115
    v_add_f32 v214, v214, v116
    v_add_f32 v215, v215, v117
    v_add_f32 v214, v214, v118
    v_add_f32 v215, v215, v119
    ds_read_b64_tr_b16 v[164:165], v201 offset:8192
    ds_read_b64_tr_b16 v[166:167], v201 offset:10240
    s_waitcnt lgkmcnt(10)
    v_mfma_f32_32x32x16_bf16 v[0:15], v[176:179], v[104:107], v[0:15]
    v_cvt_pk_bf16_f32 v112, v112, v113
    v_cvt_pk_bf16_f32 v113, v114, v115
    v_cvt_pk_bf16_f32 v114, v116, v117
    v_cvt_pk_bf16_f32 v115, v118, v119
    v_fma_f32 v120, v120, s51, -v212
    ds_read_b64_tr_b16 v[168:169], v202 offset:8192
    ds_read_b64_tr_b16 v[170:171], v202 offset:10240
    s_waitcnt lgkmcnt(10)
    v_mfma_f32_32x32x16_bf16 v[16:31], v[180:183], v[104:107], v[16:31]
    v_fma_f32 v121, v121, s51, -v212
    v_fma_f32 v122, v122, s51, -v212
    v_fma_f32 v123, v123, s51, -v212
    v_fma_f32 v124, v124, s51, -v212
    ds_read_b64_tr_b16 v[172:173], v203 offset:8192
    ds_read_b64_tr_b16 v[174:175], v203 offset:10240
    s_waitcnt lgkmcnt(10)
    v_mfma_f32_32x32x16_bf16 v[32:47], v[184:187], v[104:107], v[32:47]
    v_fma_f32 v125, v125, s51, -v212
    v_fma_f32 v126, v126, s51, -v212
    v_fma_f32 v127, v127, s51, -v212
    v_exp_f32 v120, v120
    v_exp_f32 v121, v121
    s_setprio 0
    ds_read_b64_tr_b16 v[176:177], v200 offset:12288
    ds_read_b64_tr_b16 v[178:179], v200 offset:14336
    s_waitcnt lgkmcnt(10)
    v_mfma_f32_32x32x16_bf16 v[48:63], v[188:191], v[104:107], v[48:63]
    v_exp_f32 v122, v122
    v_exp_f32 v123, v123
    v_exp_f32 v124, v124
    v_exp_f32 v125, v125
    v_exp_f32 v126, v126
    ds_read_b64_tr_b16 v[180:181], v201 offset:12288
    ds_read_b64_tr_b16 v[182:183], v201 offset:14336
    s_waitcnt lgkmcnt(10)
    v_mfma_f32_32x32x16_bf16 v[0:15], v[160:163], v[112:115], v[0:15]
    v_exp_f32 v127, v127
    v_add_f32 v214, v214, v120
    v_add_f32 v215, v215, v121
    v_add_f32 v214, v214, v122
    ds_read_b64_tr_b16 v[184:185], v202 offset:12288
    ds_read_b64_tr_b16 v[186:187], v202 offset:14336
    s_waitcnt lgkmcnt(10)
    v_mfma_f32_32x32x16_bf16 v[16:31], v[164:167], v[112:115], v[16:31]
    v_add_f32 v215, v215, v123
    v_add_f32 v214, v214, v124
    v_add_f32 v215, v215, v125
    v_add_f32 v214, v214, v126
    v_add_f32 v215, v215, v127
    ds_read_b64_tr_b16 v[188:189], v203 offset:12288
    ds_read_b64_tr_b16 v[190:191], v203 offset:14336
    s_waitcnt lgkmcnt(10)
    v_mfma_f32_32x32x16_bf16 v[32:47], v[168:171], v[112:115], v[32:47]
    v_cvt_pk_bf16_f32 v120, v120, v121
    v_cvt_pk_bf16_f32 v121, v122, v123
    v_cvt_pk_bf16_f32 v122, v124, v125
    v_cvt_pk_bf16_f32 v123, v126, v127
    s_setprio 3
    s_barrier
    ds_read_b128 v[160:163], v192 offset:32768
    s_waitcnt lgkmcnt(9)
    v_mfma_f32_32x32x16_bf16 v[48:63], v[172:175], v[112:115], v[48:63]
    v_max3_f32 v216, v128, v129, v130
    v_max3_f32 v216, v216, v131, v132
    v_max3_f32 v216, v216, v133, v134
    v_max3_f32 v216, v216, v135, v136
    ds_read_b128 v[164:167], v193 offset:32768
    s_waitcnt lgkmcnt(8)
    v_mfma_f32_32x32x16_bf16 v[0:15], v[176:179], v[120:123], v[0:15]
    v_max3_f32 v216, v216, v137, v138
    v_max3_f32 v216, v216, v139, v140
    v_max3_f32 v216, v216, v141, v142
    v_max_f32 v216, v216, v143
    ds_read_b128 v[168:171], v194 offset:32768
    s_waitcnt lgkmcnt(7)
    v_mfma_f32_32x32x16_bf16 v[16:31], v[180:183], v[120:123], v[16:31]
    v_max3_f32 v217, v144, v145, v146
    v_max3_f32 v217, v217, v147, v148
    v_max3_f32 v217, v217, v149, v150
    v_max3_f32 v217, v217, v151, v152
    ds_read_b128 v[172:175], v195 offset:32768
    s_waitcnt lgkmcnt(6)
    v_mfma_f32_32x32x16_bf16 v[32:47], v[184:187], v[120:123], v[32:47]
    v_max3_f32 v217, v217, v153, v154
    v_max3_f32 v217, v217, v155, v156
    v_max3_f32 v217, v217, v157, v158
    v_max_f32 v217, v217, v159
    s_setprio 2
    ds_read_b128 v[176:179], v196 offset:32768
    s_waitcnt lgkmcnt(5)
    v_mfma_f32_32x32x16_bf16 v[48:63], v[188:191], v[120:123], v[48:63]
    v_max_f32 v216, v216, v217
    v_mov_b32 v217, v216
    s_nop 1
    v_permlane32_swap_b32 v216, v217
    v_max_f32 v216, v216, v217
    ds_read_b128 v[180:183], v197 offset:32768
    s_waitcnt lgkmcnt(5)
    v_mfma_f32_32x32x16_bf16 v[96:111], v[160:163], v[64:67], 0
    v_cmp_gt_f32 vcc, v216, v213
    s_cbranch_vccnz gqa_attn_kernel_rare1
gqa_attn_kernel_back1:
    v_fma_f32 v128, v128, s51, -v212
    v_fma_f32 v129, v129, s51, -v212
    v_fma_f32 v130, v130, s51, -v212
    v_fma_f32 v131, v131, s51, -v212
    ds_read_b128 v[184:187], v198 offset:32768
    s_waitcnt lgkmcnt(5)
    v_mfma_f32_32x32x16_bf16 v[96:111], v[164:167], v[68:71], v[96:111]
    v_fma_f32 v132, v132, s51, -v212
    v_fma_f32 v133, v133, s51, -v212
    v_fma_f32 v134, v134, s51, -v212
    v_fma_f32 v135, v135, s51, -v212
    ds_read_b128 v[188:191], v199 offset:32768
    s_waitcnt lgkmcnt(5)
    v_mfma_f32_32x32x16_bf16 v[96:111], v[168:171], v[72:75], v[96:111]
    v_exp_f32 v128, v128
    v_exp_f32 v129, v129
    v_exp_f32 v130, v130
    v_exp_f32 v131, v131
    s_setprio 1
    ds_read_b128 v[160:163], v192 offset:40960
    s_waitcnt lgkmcnt(5)
    v_mfma_f32_32x32x16_bf16 v[96:111], v[172:175], v[76:79], v[96:111]
    v_exp_f32 v132, v132
    v_exp_f32 v133, v133
    v_exp_f32 v134, v134
    v_exp_f32 v135, v135
    ds_read_b128 v[164:167], v193 offset:40960
    s_waitcnt lgkmcnt(5)
    v_mfma_f32_32x32x16_bf16 v[96:111], v[176:179], v[80:83], v[96:111]
    v_add_f32 v214, v214, v128
    v_add_f32 v215, v215, v129
    v_add_f32 v214, v214, v130
    v_add_f32 v215, v215, v131
    ds_read_b128 v[168:171], v194 offset:40960
    s_waitcnt lgkmcnt(5)
    v_mfma_f32_32x32x16_bf16 v[96:111], v[180:183], v[84:87], v[96:111]
    v_add_f32 v214, v214, v132
    v_add_f32 v215, v215, v133
    v_add_f32 v214, v214, v134
    v_add_f32 v215, v215, v135
    v_cvt_pk_bf16_f32 v128, v128, v129
    ds_read_b128 v[172:175], v195 offset:40960
    s_waitcnt lgkmcnt(5)
    v_mfma_f32_32x32x16_bf16 v[96:111], v[184:187], v[88:91], v[96:111]
    v_cvt_pk_bf16_f32 v129, v130, v131
    v_cvt_pk_bf16_f32 v130, v132, v133
    v_cvt_pk_bf16_f32 v131, v134, v135
    v_fma_f32 v136, v136, s51, -v212
    s_setprio 0
    ds_read_b128 v[176:179], v196 offset:40960
    s_waitcnt lgkmcnt(5)
    v_mfma_f32_32x32x16_bf16 v[96:111], v[188:191], v[92:95], v[96:111]
    v_fma_f32 v137, v137, s51, -v212
    v_fma_f32 v138, v138, s51, -v212
    v_fma_f32 v139, v139, s51, -v212
    v_fma_f32 v140, v140, s51, -v212
    ds_read_b128 v[180:183], v197 offset:40960
    s_waitcnt lgkmcnt(5)
    v_mfma_f32_32x32x16_bf16 v[112:127], v[160:163], v[64:67], 0
    v_fma_f32 v141, v141, s51, -v212
    v_fma_f32 v142, v142, s51, -v212
    v_fma_f32 v143, v143, s51, -v212
    v_exp_f32 v136, v136
    ds_read_b128 v[184:187], v198 offset:40960
    s_waitcnt lgkmcnt(5)
    v_mfma_f32_32x32x16_bf16 v[112:127], v[164:167], v[68:71], v[112:127]
    v_exp_f32 v137, v137
    v_exp_f32 v138, v138
    v_exp_f32 v139, v139
    v_exp_f32 v140, v140
    ds_read_b128 v[188:191], v199 offset:40960
    s_waitcnt lgkmcnt(5)
    v_mfma_f32_32x32x16_bf16 v[112:127], v[168:171], v[72:75], v[112:127]
    v_exp_f32 v141, v141
    v_exp_f32 v142, v142
    v_exp_f32 v143, v143
    v_add_f32 v214, v214, v136
    v_add_f32 v215, v215, v137
    s_setprio 3
    s_waitcnt vmcnt(4)
    s_barrier
    ds_read_b64_tr_b16 v[160:161], v200 offset:16384
    ds_read_b64_tr_b16 v[162:163], v200 offset:18432
    s_waitcnt lgkmcnt(6)
    v_mfma_f32_32x32x16_bf16 v[112:127], v[172:175], v[76:79], v[112:127]
    v_add_f32 v214, v214, v138
    v_add_f32 v215, v215, v139
    v_add_f32 v214, v214, v140
    v_add_f32 v215, v215, v141
    s_add_u32 s50, s48, 0x8000
    s_add_u32 m0, s49, 0x18000
    s_nop 0
    buffer_load_dwordx4 v206, s[28:31], s50 offen lds
    ds_read_b64_tr_b16 v[164:165], v201 offset:16384
    ds_read_b64_tr_b16 v[166:167], v201 offset:18432
    s_waitcnt lgkmcnt(7)
    v_mfma_f32_32x32x16_bf16 v[112:127], v[176:179], v[80:83], v[112:127]
    v_add_f32 v214, v214, v142
    v_add_f32 v215, v215, v143
    v_cvt_pk_bf16_f32 v136, v136, v137
    v_cvt_pk_bf16_f32 v137, v138, v139
    s_add_u32 s50, s48, 0x8000
    s_add_u32 m0, s49, 0x18000
    s_nop 0
    buffer_load_dwordx4 v206, s[28:31], s50 offen offset:1024 lds
    ds_read_b64_tr_b16 v[168:169], v202 offset:16384
    ds_read_b64_tr_b16 v[170:171], v202 offset:18432
    s_waitcnt lgkmcnt(8)
    v_mfma_f32_32x32x16_bf16 v[112:127], v[180:183], v[84:87], v[112:127]
    v_cvt_pk_bf16_f32 v138, v140, v141
    v_cvt_pk_bf16_f32 v139, v142, v143
    v_fma_f32 v144, v144, s51, -v212
    v_fma_f32 v145, v145, s51, -v212
    s_add_u32 s50, s48, 0x18000
    s_add_u32 m0, s49, 0x20000
    s_nop 0
    buffer_load_dwordx4 v206, s[28:31], s50 offen lds
    ds_read_b64_tr_b16 v[172:173], v203 offset:16384
    ds_read_b64_tr_b16 v[174:175], v203 offset:18432
    s_waitcnt lgkmcnt(9)
    v_mfma_f32_32x32x16_bf16 v[112:127], v[184:187], v[88:91], v[112:127]
    v_fma_f32 v146, v146, s51, -v212
    v_fma_f32 v147, v147, s51, -v212
    v_fma_f32 v148, v148, s51, -v212
    v_fma_f32 v149, v149, s51, -v212
    s_add_u32 s50, s48, 0x18000
    s_add_u32 m0, s49, 0x20000
    s_nop 0
    buffer_load_dwordx4 v206, s[28:31], s50 offen offset:1024 lds
    s_setprio 2
    ds_read_b64_tr_b16 v[176:177], v200 offset:20480
    ds_read_b64_tr_b16 v[178:179], v200 offset:22528
    s_waitcnt lgkmcnt(10)
    v_mfma_f32_32x32x16_bf16 v[112:127], v[188:191], v[92:95], v[112:127]
    v_fma_f32 v150, v150, s51, -v212
    v_fma_f32 v151, v151, s51, -v212
    v_exp_f32 v144, v144
    v_exp_f32 v145, v145
    ds_read_b64_tr_b16 v[180:181], v201 offset:20480
    ds_read_b64_tr_b16 v[182:183], v201 offset:22528
    s_waitcnt lgkmcnt(10)
    v_mfma_f32_32x32x16_bf16 v[0:15], v[160:163], v[128:131], v[0:15]
    v_exp_f32 v146, v146
    v_exp_f32 v147, v147
    v_exp_f32 v148, v148
    v_exp_f32 v149, v149
    v_exp_f32 v150, v150
    ds_read_b64_tr_b16 v[184:185], v202 offset:20480
    ds_read_b64_tr_b16 v[186:187], v202 offset:22528
    s_waitcnt lgkmcnt(10)
    v_mfma_f32_32x32x16_bf16 v[16:31], v[164:167], v[128:131], v[16:31]
    v_exp_f32 v151, v151
    v_add_f32 v214, v214, v144
    v_add_f32 v215, v215, v145
    v_add_f32 v214, v214, v146
    ds_read_b64_tr_b16 v[188:189], v203 offset:20480
    ds_read_b64_tr_b16 v[190:191], v203 offset:22528
    s_waitcnt lgkmcnt(10)
    v_mfma_f32_32x32x16_bf16 v[32:47], v[168:171], v[128:131], v[32:47]
    v_add_f32 v215, v215, v147
    v_add_f32 v214, v214, v148
    v_add_f32 v215, v215, v149
    v_add_f32 v214, v214, v150
    s_setprio 1
    ds_read_b64_tr_b16 v[160:161], v200 offset:24576
    ds_read_b64_tr_b16 v[162:163], v200 offset:26624
    s_waitcnt lgkmcnt(10)
    v_mfma_f32_32x32x16_bf16 v[48:63], v[172:175], v[128:131], v[48:63]
    v_add_f32 v215, v215, v151
    v_cvt_pk_bf16_f32 v144, v144, v145
    v_cvt_pk_bf16_f32 v145, v146, v147
    v_cvt_pk_bf16_f32 v146, v148, v149
    ds_read_b64_tr_b16 v[164:165], v201 offset:24576
    ds_read_b64_tr_b16 v[166:167], v201 offset:26624
    s_waitcnt lgkmcnt(10)
    v_mfma_f32_32x32x16_bf16 v[0:15], v[176:179], v[136:139], v[0:15]
    v_cvt_pk_bf16_f32 v147, v150, v151
    v_fma_f32 v152, v152, s51, -v212
    v_fma_f32 v153, v153, s51, -v212
    v_fma_f32 v154, v154, s51, -v212
    ds_read_b64_tr_b16 v[168:169], v202 offset:24576
    ds_read_b64_tr_b16 v[170:171], v202 offset:26624
    s_waitcnt lgkmcnt(10)
    v_mfma_f32_32x32x16_bf16 v[16:31], v[180:183], v[136:139], v[16:31]
    v_fma_f32 v155, v155, s51, -v212
    v_fma_f32 v156, v156, s51, -v212
    v_fma_f32 v157, v157, s51, -v212
    v_fma_f32 v158, v158, s51, -v212
    v_fma_f32 v159, v159, s51, -v212
    ds_read_b64_tr_b16 v[172:173], v203 offset:24576
    ds_read_b64_tr_b16 v[174:175], v203 offset:26624
    s_waitcnt lgkmcnt(10)
    v_mfma_f32_32x32x16_bf16 v[32:47], v[184:187], v[136:139], v[32:47]
    v_exp_f32 v152, v152
    v_exp_f32 v153, v153
    v_exp_f32 v154, v154
    v_exp_f32 v155, v155
    s_setprio 0
    ds_read_b64_tr_b16 v[176:177], v200 offset:28672
    ds_read_b64_tr_b16 v[178:179], v200 offset:30720
    s_waitcnt lgkmcnt(10)
    v_mfma_f32_32x32x16_bf16 v[48:63], v[188:191], v[136:139], v[48:63]
    v_exp_f32 v156, v156
    v_exp_f32 v157, v157
    v_exp_f32 v158, v158
    v_exp_f32 v159, v159
    ds_read_b64_tr_b16 v[180:181], v201 offset:28672
    ds_read_b64_tr_b16 v[182:183], v201 offset:30720
    s_waitcnt lgkmcnt(10)
    v_mfma_f32_32x32x16_bf16 v[0:15], v[160:163], v[144:147], v[0:15]
    v_add_f32 v214, v214, v152
    v_add_f32 v215, v215, v153
    v_add_f32 v214, v214, v154
    v_add_f32 v215, v215, v155
    ds_read_b64_tr_b16 v[184:185], v202 offset:28672
    ds_read_b64_tr_b16 v[186:187], v202 offset:30720
    s_waitcnt lgkmcnt(10)
    v_mfma_f32_32x32x16_bf16 v[16:31], v[164:167], v[144:147], v[16:31]
    v_add_f32 v214, v214, v156
    v_add_f32 v215, v215, v157
    v_add_f32 v214, v214, v158
    v_add_f32 v215, v215, v159
    ds_read_b64_tr_b16 v[188:189], v203 offset:28672
    ds_read_b64_tr_b16 v[190:191], v203 offset:30720
    s_waitcnt lgkmcnt(10)
    v_mfma_f32_32x32x16_bf16 v[32:47], v[168:171], v[144:147], v[32:47]
    v_cvt_pk_bf16_f32 v152, v152, v153
    v_cvt_pk_bf16_f32 v153, v154, v155
    v_cvt_pk_bf16_f32 v154, v156, v157
    v_cvt_pk_bf16_f32 v155, v158, v159
    s_setprio 3
    s_waitcnt vmcnt(6)
    s_waitcnt vmcnt(4)
    s_barrier
    ds_read_b128 v[160:163], v192 offset:0
    s_waitcnt lgkmcnt(9)
    v_mfma_f32_32x32x16_bf16 v[48:63], v[172:175], v[144:147], v[48:63]
    v_max3_f32 v216, v96, v97, v98
    v_max3_f32 v216, v216, v99, v100
    v_max3_f32 v216, v216, v101, v102
    v_max3_f32 v216, v216, v103, v104
    ds_read_b128 v[164:167], v193 offset:0
    s_waitcnt lgkmcnt(8)
    v_mfma_f32_32x32x16_bf16 v[0:15], v[176:179], v[152:155], v[0:15]
    v_max3_f32 v216, v216, v105, v106
    v_max3_f32 v216, v216, v107, v108
    v_max3_f32 v216, v216, v109, v110
    v_max_f32 v216, v216, v111
    ds_read_b128 v[168:171], v194 offset:0
    s_waitcnt lgkmcnt(7)
    v_mfma_f32_32x32x16_bf16 v[16:31], v[180:183], v[152:155], v[16:31]
    v_max3_f32 v217, v112, v113, v114
    v_max3_f32 v217, v217, v115, v116
    v_max3_f32 v217, v217, v117, v118
    v_max3_f32 v217, v217, v119, v120
    ds_read_b128 v[172:175], v195 offset:0
    s_waitcnt lgkmcnt(6)
    v_mfma_f32_32x32x16_bf16 v[32:47], v[184:187], v[152:155], v[32:47]
    v_max3_f32 v217, v217, v121, v122
    v_max3_f32 v217, v217, v123, v124
    v_max3_f32 v217, v217, v125, v126
    v_max_f32 v217, v217, v127
    s_setprio 2
    ds_read_b128 v[176:179], v196 offset:0
    s_waitcnt lgkmcnt(5)
    v_mfma_f32_32x32x16_bf16 v[48:63], v[188:191], v[152:155], v[48:63]
    v_max_f32 v216, v216, v217
    v_mov_b32 v217, v216
    s_nop 1
    v_permlane32_swap_b32 v216, v217
    v_max_f32 v216, v216, v217
    ds_read_b128 v[180:183], v197 offset:0
    s_waitcnt lgkmcnt(5)
    v_mfma_f32_32x32x16_bf16 v[128:143], v[160:163], v[64:67], 0
    v_cmp_gt_f32 vcc, v216, v213
    s_cbranch_vccnz gqa_attn_kernel_rare2
gqa_attn_kernel_back2:
    v_fma_f32 v96, v96, s51, -v212
    v_fma_f32 v97, v97, s51, -v212
    v_fma_f32 v98, v98, s51, -v212
    v_fma_f32 v99, v99, s51, -v212
    ds_read_b128 v[184:187], v198 offset:0
    s_waitcnt lgkmcnt(5)
    v_mfma_f32_32x32x16_bf16 v[128:143], v[164:167], v[68:71], v[128:143]
    v_fma_f32 v100, v100, s51, -v212
    v_fma_f32 v101, v101, s51, -v212
    v_fma_f32 v102, v102, s51, -v212
    v_fma_f32 v103, v103, s51, -v212
    ds_read_b128 v[188:191], v199 offset:0
    s_waitcnt lgkmcnt(5)
    v_mfma_f32_32x32x16_bf16 v[128:143], v[168:171], v[72:75], v[128:143]
    v_exp_f32 v96, v96
    v_exp_f32 v97, v97
    v_exp_f32 v98, v98
    v_exp_f32 v99, v99
    s_setprio 1
    ds_read_b128 v[160:163], v192 offset:8192
    s_waitcnt lgkmcnt(5)
    v_mfma_f32_32x32x16_bf16 v[128:143], v[172:175], v[76:79], v[128:143]
    v_exp_f32 v100, v100
    v_exp_f32 v101, v101
    v_exp_f32 v102, v102
    v_exp_f32 v103, v103
    ds_read_b128 v[164:167], v193 offset:8192
    s_waitcnt lgkmcnt(5)
    v_mfma_f32_32x32x16_bf16 v[128:143], v[176:179], v[80:83], v[128:143]
    v_add_f32 v214, v214, v96
    v_add_f32 v215, v215, v97
    v_add_f32 v214, v214, v98
    v_add_f32 v215, v215, v99
    ds_read_b128 v[168:171], v194 offset:8192
    s_waitcnt lgkmcnt(5)
    v_mfma_f32_32x32x16_bf16 v[128:143], v[180:183], v[84:87], v[128:143]
    v_add_f32 v214, v214, v100
    v_add_f32 v215, v215, v101
    v_add_f32 v214, v214, v102
    v_add_f32 v215, v215, v103
    v_cvt_pk_bf16_f32 v96, v96, v97
    ds_read_b128 v[172:175], v195 offset:8192
    s_waitcnt lgkmcnt(5)
    v_mfma_f32_32x32x16_bf16 v[128:143], v[184:187], v[88:91], v[128:143]
    v_cvt_pk_bf16_f32 v97, v98, v99
    v_cvt_pk_bf16_f32 v98, v100, v101
    v_cvt_pk_bf16_f32 v99, v102, v103
    v_fma_f32 v104, v104, s51, -v212
    s_setprio 0
    ds_read_b128 v[176:179], v196 offset:8192
    s_waitcnt lgkmcnt(5)
    v_mfma_f32_32x32x16_bf16 v[128:143], v[188:191], v[92:95], v[128:143]
    v_fma_f32 v105, v105, s51, -v212
    v_fma_f32 v106, v106, s51, -v212
    v_fma_f32 v107, v107, s51, -v212
    v_fma_f32 v108, v108, s51, -v212
    ds_read_b128 v[180:183], v197 offset:8192
    s_waitcnt lgkmcnt(5)
    v_mfma_f32_32x32x16_bf16 v[144:159], v[160:163], v[64:67], 0
    v_fma_f32 v109, v109, s51, -v212
    v_fma_f32 v110, v110, s51, -v212
    v_fma_f32 v111, v111, s51, -v212
    v_exp_f32 v104, v104
    ds_read_b128 v[184:187], v198 offset:8192
    s_waitcnt lgkmcnt(5)
    v_mfma_f32_32x32x16_bf16 v[144:159], v[164:167], v[68:71], v[144:159]
    v_exp_f32 v105, v105
    v_exp_f32 v106, v106
    v_exp_f32 v107, v107
    v_exp_f32 v108, v108
    ds_read_b128 v[188:191], v199 offset:8192
    s_waitcnt lgkmcnt(5)
    v_mfma_f32_32x32x16_bf16 v[144:159], v[168:171], v[72:75], v[144:159]
    v_exp_f32 v109, v109
    v_exp_f32 v110, v110
    v_exp_f32 v111, v111
    v_add_f32 v214, v214, v104
    v_add_f32 v215, v215, v105
    s_setprio 3
    s_waitcnt vmcnt(2)
    s_waitcnt vmcnt(0)
    s_barrier
    ds_read_b64_tr_b16 v[160:161], v200 offset:0
    ds_read_b64_tr_b16 v[162:163], v200 offset:2048
    s_waitcnt lgkmcnt(6)
    v_mfma_f32_32x32x16_bf16 v[144:159], v[172:175], v[76:79], v[144:159]
    v_add_f32 v214, v214, v106
    v_add_f32 v215, v215, v107
    v_add_f32 v214, v214, v108
    v_add_f32 v215, v215, v109
    s_add_u32 s50, s48, 0xc000
    s_add_u32 m0, s49, 0x1c000
    s_nop 0
    buffer_load_dwordx4 v206, s[28:31], s50 offen lds
    ds_read_b64_tr_b16 v[164:165], v201 offset:0
    ds_read_b64_tr_b16 v[166:167], v201 offset:2048
    s_waitcnt lgkmcnt(7)
    v_mfma_f32_32x32x16_bf16 v[144:159], v[176:179], v[80:83], v[144:159]
    v_add_f32 v214, v214, v110
    v_add_f32 v215, v215, v111
    v_cvt_pk_bf16_f32 v104, v104, v105
    v_cvt_pk_bf16_f32 v105, v106, v107
    s_add_u32 s50, s48, 0xc000
    s_add_u32 m0, s49, 0x1c000
    s_nop 0
    buffer_load_dwordx4 v206, s[28:31], s50 offen offset:1024 lds
    ds_read_b64_tr_b16 v[168:169], v202 offset:0
    ds_read_b64_tr_b16 v[170:171], v202 offset:2048
    s_waitcnt lgkmcnt(8)
    v_mfma_f32_32x32x16_bf16 v[144:159], v[180:183], v[84:87], v[144:159]
    v_cvt_pk_bf16_f32 v106, v108, v109
    v_cvt_pk_bf16_f32 v107, v110, v111
    v_fma_f32 v112, v112, s51, -v212
    v_fma_f32 v113, v113, s51, -v212
    s_add_u32 s50, s48, 0x1c000
    s_add_u32 m0, s49, 0x24000
    s_nop 0
    buffer_load_dwordx4 v206, s[28:31], s50 offen lds
    ds_read_b64_tr_b16 v[172:173], v203 offset:0
    ds_read_b64_tr_b16 v[174:175], v203 offset:2048
    s_waitcnt lgkmcnt(9)
    v_mfma_f32_32x32x16_bf16 v[144:159], v[184:187], v[88:91], v[144:159]
    v_fma_f32 v114, v114, s51, -v212
    v_fma_f32 v115, v115, s51, -v212
    v_fma_f32 v116, v116, s51, -v212
    v_fma_f32 v117, v117, s51, -v212
    s_add_u32 s50, s48, 0x1c000
    s_add_u32 m0, s49, 0x24000
    s_nop 0
    buffer_load_dwordx4 v206, s[28:31], s50 offen offset:1024 lds
    s_setprio 2
    ds_read_b64_tr_b16 v[176:177], v200 offset:4096
    ds_read_b64_tr_b16 v[178:179], v200 offset:6144
    s_waitcnt lgkmcnt(10)
    v_mfma_f32_32x32x16_bf16 v[144:159], v[188:191], v[92:95], v[144:159]
    v_fma_f32 v118, v118, s51, -v212
    v_fma_f32 v119, v119, s51, -v212
    v_exp_f32 v112, v112
    v_exp_f32 v113, v113
    ds_read_b64_tr_b16 v[180:181], v201 offset:4096
    ds_read_b64_tr_b16 v[182:183], v201 offset:6144
    s_waitcnt lgkmcnt(10)
    v_mfma_f32_32x32x16_bf16 v[0:15], v[160:163], v[96:99], v[0:15]
    v_exp_f32 v114, v114
    v_exp_f32 v115, v115
    v_exp_f32 v116, v116
    v_exp_f32 v117, v117
    v_exp_f32 v118, v118
    ds_read_b64_tr_b16 v[184:185], v202 offset:4096
    ds_read_b64_tr_b16 v[186:187], v202 offset:6144
    s_waitcnt lgkmcnt(10)
    v_mfma_f32_32x32x16_bf16 v[16:31], v[164:167], v[96:99], v[16:31]
    v_exp_f32 v119, v119
    v_add_f32 v214, v214, v112
    v_add_f32 v215, v215, v113
    v_add_f32 v214, v214, v114
    ds_read_b64_tr_b16 v[188:189], v203 offset:4096
    ds_read_b64_tr_b16 v[190:191], v203 offset:6144
    s_waitcnt lgkmcnt(10)
    v_mfma_f32_32x32x16_bf16 v[32:47], v[168:171], v[96:99], v[32:47]
    v_add_f32 v215, v215, v115
    v_add_f32 v214, v214, v116
    v_add_f32 v215, v215, v117
    v_add_f32 v214, v214, v118
    s_setprio 1
    ds_read_b64_tr_b16 v[160:161], v200 offset:8192
    ds_read_b64_tr_b16 v[162:163], v200 offset:10240
    s_waitcnt lgkmcnt(10)
    v_mfma_f32_32x32x16_bf16 v[48:63], v[172:175], v[96:99], v[48:63]
    v_add_f32 v215, v215, v119
    v_cvt_pk_bf16_f32 v112, v112, v113
    v_cvt_pk_bf16_f32 v113, v114, v115
    v_cvt_pk_bf16_f32 v114, v116, v117
    ds_read_b64_tr_b16 v[164:165], v201 offset:8192
    ds_read_b64_tr_b16 v[166:167], v201 offset:10240
    s_waitcnt lgkmcnt(10)
    v_mfma_f32_32x32x16_bf16 v[0:15], v[176:179], v[104:107], v[0:15]
    v_cvt_pk_bf16_f32 v115, v118, v119
    v_fma_f32 v120, v120, s51, -v212
    v_fma_f32 v121, v121, s51, -v212
    v_fma_f32 v122, v122, s51, -v212
    ds_read_b64_tr_b16 v[168:169], v202 offset:8192
    ds_read_b64_tr_b16 v[170:171], v202 offset:10240
    s_waitcnt lgkmcnt(10)
    v_mfma_f32_32x32x16_bf16 v[16:31], v[180:183], v[104:107], v[16:31]
    v_fma_f32 v123, v123, s51, -v212
    v_fma_f32 v124, v124, s51, -v212
    v_fma_f32 v125, v125, s51, -v212
    v_fma_f32 v126, v126, s51, -v212
    v_fma_f32 v127, v127, s51, -v212
    ds_read_b64_tr_b16 v[172:173], v203 offset:8192
    ds_read_b64_tr_b16 v[174:175], v203 offset:10240
    s_waitcnt lgkmcnt(10)
    v_mfma_f32_32x32x16_bf16 v[32:47], v[184:187], v[104:107], v[32:47]
    v_exp_f32 v120, v120
    v_exp_f32 v121, v121
    v_exp_f32 v122, v122
    v_exp_f32 v123, v123
    s_setprio 0
    ds_read_b64_tr_b16 v[176:177], v200 offset:12288
    ds_read_b64_tr_b16 v[178:179], v200 offset:14336
    s_waitcnt lgkmcnt(10)
    v_mfma_f32_32x32x16_bf16 v[48:63], v[188:191], v[104:107], v[48:63]
    v_exp_f32 v124, v124
    v_exp_f32 v125, v125
    v_exp_f32 v126, v126
    v_exp_f32 v127, v127
    ds_read_b64_tr_b16 v[180:181], v201 offset:12288
    ds_read_b64_tr_b16 v[182:183], v201 offset:14336
    s_waitcnt lgkmcnt(10)
    v_mfma_f32_32x32x16_bf16 v[0:15], v[160:163], v[112:115], v[0:15]
    v_add_f32 v214, v214, v120
    v_add_f32 v215, v215, v121
    v_add_f32 v214, v214, v122
    v_add_f32 v215, v215, v123
    ds_read_b64_tr_b16 v[184:185], v202 offset:12288
    ds_read_b64_tr_b16 v[186:187], v202 offset:14336
    s_waitcnt lgkmcnt(10)
    v_mfma_f32_32x32x16_bf16 v[16:31], v[164:167], v[112:115], v[16:31]
    v_add_f32 v214, v214, v124
    v_add_f32 v215, v215, v125
    v_add_f32 v214, v214, v126
    v_add_f32 v215, v215, v127
    ds_read_b64_tr_b16 v[188:189], v203 offset:12288
    ds_read_b64_tr_b16 v[190:191], v203 offset:14336
    s_waitcnt lgkmcnt(10)
    v_mfma_f32_32x32x16_bf16 v[32:47], v[168:171], v[112:115], v[32:47]
    v_cvt_pk_bf16_f32 v120, v120, v121
    v_cvt_pk_bf16_f32 v121, v122, v123
    v_cvt_pk_bf16_f32 v122, v124, v125
    v_cvt_pk_bf16_f32 v123, v126, v127
    s_setprio 3
    s_waitcnt vmcnt(2)
    s_waitcnt vmcnt(0)
    s_barrier
    ds_read_b64_tr_b16 v[160:161], v200 offset:16384
    ds_read_b64_tr_b16 v[162:163], v200 offset:18432
    s_waitcnt lgkmcnt(10)
    v_mfma_f32_32x32x16_bf16 v[48:63], v[172:175], v[112:115], v[48:63]
    v_max3_f32 v216, v128, v129, v130
    v_max3_f32 v216, v216, v131, v132
    v_max3_f32 v216, v216, v133, v134
    v_max3_f32 v216, v216, v135, v136
    ds_read_b64_tr_b16 v[164:165], v201 offset:16384
    ds_read_b64_tr_b16 v[166:167], v201 offset:18432
    s_waitcnt lgkmcnt(10)
    v_mfma_f32_32x32x16_bf16 v[0:15], v[176:179], v[120:123], v[0:15]
    v_max3_f32 v216, v216, v137, v138
    v_max3_f32 v216, v216, v139, v140
    v_max3_f32 v216, v216, v141, v142
    v_max_f32 v216, v216, v143
    ds_read_b64_tr_b16 v[168:169], v202 offset:16384
    ds_read_b64_tr_b16 v[170:171], v202 offset:18432
    s_waitcnt lgkmcnt(10)
    v_mfma_f32_32x32x16_bf16 v[16:31], v[180:183], v[120:123], v[16:31]
    v_max3_f32 v217, v144, v145, v146
    v_max3_f32 v217, v217, v147, v148
    v_max3_f32 v217, v217, v149, v150
    v_max3_f32 v217, v217, v151, v152
    ds_read_b64_tr_b16 v[172:173], v203 offset:16384
    ds_read_b64_tr_b16 v[174:175], v203 offset:18432
    s_waitcnt lgkmcnt(10)
    v_mfma_f32_32x32x16_bf16 v[32:47], v[184:187], v[120:123], v[32:47]
    v_max3_f32 v217, v217, v153, v154
    v_max3_f32 v217, v217, v155, v156
    v_max3_f32 v217, v217, v157, v158
    v_max_f32 v217, v217, v159
    ds_read_b64_tr_b16 v[176:177], v200 offset:20480
    ds_read_b64_tr_b16 v[178:179], v200 offset:22528
    s_waitcnt lgkmcnt(10)
    v_mfma_f32_32x32x16_bf16 v[48:63], v[188:191], v[120:123], v[48:63]
    v_max_f32 v216, v216, v217
    v_mov_b32 v217, v216
    s_nop 1
    v_permlane32_swap_b32 v216, v217
    v_max_f32 v216, v216, v217
    ds_read_b64_tr_b16 v[180:181], v201 offset:20480
    ds_read_b64_tr_b16 v[182:183], v201 offset:22528
    v_cmp_gt_f32 vcc, v216, v213
    s_cbranch_vccnz gqa_attn_kernel_rare3
gqa_attn_kernel_back3:
    v_fma_f32 v128, v128, s51, -v212
    v_fma_f32 v129, v129, s51, -v212
    v_fma_f32 v130, v130, s51, -v212
    v_fma_f32 v131, v131, s51, -v212
    v_fma_f32 v132, v132, s51, -v212
    v_fma_f32 v133, v133, s51, -v212
    v_fma_f32 v134, v134, s51, -v212
    v_fma_f32 v135, v135, s51, -v212
    v_exp_f32 v128, v128
    v_exp_f32 v129, v129
    v_exp_f32 v130, v130
    v_exp_f32 v131, v131
    v_exp_f32 v132, v132
    v_exp_f32 v133, v133
    v_exp_f32 v134, v134
    v_exp_f32 v135, v135
    v_add_f32 v214, v214, v128
    v_add_f32 v215, v215, v129
    v_add_f32 v214, v214, v130
    v_add_f32 v215, v215, v131
    v_add_f32 v214, v214, v132
    v_add_f32 v215, v215, v133
    v_add_f32 v214, v214, v134
    v_add_f32 v215, v215, v135
    v_cvt_pk_bf16_f32 v128, v128, v129
    v_cvt_pk_bf16_f32 v129, v130, v131
    v_cvt_pk_bf16_f32 v130, v132, v133
    v_cvt_pk_bf16_f32 v131, v134, v135
    s_waitcnt lgkmcnt(10)
    s_nop 0
    v_mfma_f32_32x32x16_bf16 v[0:15], v[160:163], v[128:131], v[0:15]
    v_fma_f32 v136, v136, s51, -v212
    v_fma_f32 v137, v137, s51, -v212
    v_fma_f32 v138, v138, s51, -v212
    v_fma_f32 v139, v139, s51, -v212
    v_fma_f32 v140, v140, s51, -v212
    v_fma_f32 v141, v141, s51, -v212
    v_fma_f32 v142, v142, s51, -v212
    s_setprio 2
    ds_read_b64_tr_b16 v[184:185], v202 offset:20480
    ds_read_b64_tr_b16 v[186:187], v202 offset:22528
    s_waitcnt lgkmcnt(10)
    v_mfma_f32_32x32x16_bf16 v[16:31], v[164:167], v[128:131], v[16:31]
    v_fma_f32 v143, v143, s51, -v212
    v_exp_f32 v136, v136
    v_exp_f32 v137, v137
    v_exp_f32 v138, v138
    v_exp_f32 v139, v139
    v_exp_f32 v140, v140
    v_exp_f32 v141, v141
    ds_read_b64_tr_b16 v[188:189], v203 offset:20480
    ds_read_b64_tr_b16 v[190:191], v203 offset:22528
    s_waitcnt lgkmcnt(10)
    v_mfma_f32_32x32x16_bf16 v[32:47], v[168:171], v[128:131], v[32:47]
    v_exp_f32 v142, v142
    v_exp_f32 v143, v143
    v_add_f32 v214, v214, v136
    v_add_f32 v215, v215, v137
    v_add_f32 v214, v214, v138
    v_add_f32 v215, v215, v139
    v_add_f32 v214, v214, v140
    ds_read_b64_tr_b16 v[160:161], v200 offset:24576
    ds_read_b64_tr_b16 v[162:163], v200 offset:26624
    s_waitcnt lgkmcnt(10)
    v_mfma_f32_32x32x16_bf16 v[48:63], v[172:175], v[128:131], v[48:63]
    v_add_f32 v215, v215, v141
    v_add_f32 v214, v214, v142
    v_add_f32 v215, v215, v143
    v_cvt_pk_bf16_f32 v136, v136, v137
    v_cvt_pk_bf16_f32 v137, v138, v139
    v_cvt_pk_bf16_f32 v138, v140, v141
    v_cvt_pk_bf16_f32 v139, v142, v143
    ds_read_b64_tr_b16 v[164:165], v201 offset:24576
    ds_read_b64_tr_b16 v[166:167], v201 offset:26624
    s_waitcnt lgkmcnt(10)
    v_mfma_f32_32x32x16_bf16 v[0:15], v[176:179], v[136:139], v[0:15]
    v_fma_f32 v144, v144, s51, -v212
    v_fma_f32 v145, v145, s51, -v212
    v_fma_f32 v146, v146, s51, -v212
    v_fma_f32 v147, v147, s51, -v212
    v_fma_f32 v148, v148, s51, -v212
    v_fma_f32 v149, v149, s51, -v212
    v_fma_f32 v150, v150, s51, -v212
    ds_read_b64_tr_b16 v[168:169], v202 offset:24576
    ds_read_b64_tr_b16 v[170:171], v202 offset:26624
    s_waitcnt lgkmcnt(10)
    v_mfma_f32_32x32x16_bf16 v[16:31], v[180:183], v[136:139], v[16:31]
    v_fma_f32 v151, v151, s51, -v212
    v_exp_f32 v144, v144
    v_exp_f32 v145, v145
    v_exp_f32 v146, v146
    v_exp_f32 v147, v147
    v_exp_f32 v148, v148
    v_exp_f32 v149, v149
    s_setprio 1
    ds_read_b64_tr_b16 v[172:173], v203 offset:24576
    ds_read_b64_tr_b16 v[174:175], v203 offset:26624
    s_waitcnt lgkmcnt(10)
    v_mfma_f32_32x32x16_bf16 v[32:47], v[184:187], v[136:139], v[32:47]
    v_exp_f32 v150, v150
    v_exp_f32 v151, v151
    v_add_f32 v214, v214, v144
    v_add_f32 v215, v215, v145
    v_add_f32 v214, v214, v146
    v_add_f32 v215, v215, v147
    v_add_f32 v214, v214, v148
    ds_read_b64_tr_b16 v[176:177], v200 offset:28672
    ds_read_b64_tr_b16 v[178:179], v200 offset:30720
    s_waitcnt lgkmcnt(10)
    v_mfma_f32_32x32x16_bf16 v[48:63], v[188:191], v[136:139], v[48:63]
    v_add_f32 v215, v215, v149
    v_add_f32 v214, v214, v150
    v_add_f32 v215, v215, v151
    v_cvt_pk_bf16_f32 v144, v144, v145
    v_cvt_pk_bf16_f32 v145, v146, v147
    v_cvt_pk_bf16_f32 v146, v148, v149
    v_cvt_pk_bf16_f32 v147, v150, v151
    ds_read_b64_tr_b16 v[180:181], v201 offset:28672
    ds_read_b64_tr_b16 v[182:183], v201 offset:30720
    s_waitcnt lgkmcnt(10)
    v_mfma_f32_32x32x16_bf16 v[0:15], v[160:163], v[144:147], v[0:15]
    v_fma_f32 v152, v152, s51, -v212
    v_fma_f32 v153, v153, s51, -v212
    v_fma_f32 v154, v154, s51, -v212
    v_fma_f32 v155, v155, s51, -v212
    v_fma_f32 v156, v156, s51, -v212
    v_fma_f32 v157, v157, s51, -v212
    v_fma_f32 v158, v158, s51, -v212
    ds_read_b64_tr_b16 v[184:185], v202 offset:28672
    ds_read_b64_tr_b16 v[186:187], v202 offset:30720
    s_waitcnt lgkmcnt(10)
    v_mfma_f32_32x32x16_bf16 v[16:31], v[164:167], v[144:147], v[16:31]
    v_fma_f32 v159, v159, s51, -v212
    v_exp_f32 v152, v152
    v_exp_f32 v153, v153
    v_exp_f32 v154, v154
    v_exp_f32 v155, v155
    v_exp_f32 v156, v156
    v_exp_f32 v157, v157
    ds_read_b64_tr_b16 v[188:189], v203 offset:28672
    ds_read_b64_tr_b16 v[190:191], v203 offset:30720
    s_waitcnt lgkmcnt(10)
    v_mfma_f32_32x32x16_bf16 v[32:47], v[168:171], v[144:147], v[32:47]
    v_exp_f32 v158, v158
    v_exp_f32 v159, v159
    v_add_f32 v214, v214, v152
    v_add_f32 v215, v215, v153
    v_add_f32 v214, v214, v154
    v_add_f32 v215, v215, v155
    v_add_f32 v214, v214, v156
    s_setprio 0
    s_waitcnt lgkmcnt(8)
    v_mfma_f32_32x32x16_bf16 v[48:63], v[172:175], v[144:147], v[48:63]
    v_add_f32 v215, v215, v157
    v_add_f32 v214, v214, v158
    v_add_f32 v215, v215, v159
    v_cvt_pk_bf16_f32 v152, v152, v153
    v_cvt_pk_bf16_f32 v153, v154, v155
    v_cvt_pk_bf16_f32 v154, v156, v157
    v_cvt_pk_bf16_f32 v155, v158, v159
    s_waitcnt lgkmcnt(6)
    s_nop 0
    v_mfma_f32_32x32x16_bf16 v[0:15], v[176:179], v[152:155], v[0:15]
    s_waitcnt lgkmcnt(4)
    v_mfma_f32_32x32x16_bf16 v[16:31], v[180:183], v[152:155], v[16:31]
    s_waitcnt lgkmcnt(2)
    v_mfma_f32_32x32x16_bf16 v[32:47], v[184:187], v[152:155], v[32:47]
    s_waitcnt lgkmcnt(0)
    v_mfma_f32_32x32x16_bf16 v[48:63], v[188:191], v[152:155], v[48:63]
    v_mbcnt_lo_u32_b32 v230, -1, 0
    v_mbcnt_hi_u32_b32 v230, -1, v230
    v_lshlrev_b32 v230, 4, v230
    s_mul_i32 s61, s2, 18432
    s_lshl_b32 s62, s46, 10
    s_add_u32 s61, s61, s62
    s_mov_b32 s92, s12
    s_and_b32 s93, s13, 0xffff
    s_mov_b32 s94, 4718592
    s_mov_b32 s95, 0x00020000
    buffer_load_dwordx4 v[128:131], v230, s[92:95], s61 offen
    s_add_u32 s61, s61, 8192
    buffer_load_dwordx4 v[132:135], v230, s[92:95], s61 offen
    s_add_u32 s61, s61, 8192
    buffer_load_dwordx4 v[136:139], v230, s[92:95], s61 offen
    v_add_f32 v214, v214, v215
    v_mov_b32 v215, v214
    s_nop 1
    v_permlane32_swap_b32 v214, v215
    v_add_f32 v214, v214, v215
    v_mov_b32 v215, v211
    s_lshl_b32 s52, s46, 13
    v_add_u32 v220, s52, v218
    s_xor_b32 s53, s46, 4
    s_lshl_b32 s54, s53, 13
    v_add_u32 v221, s54, v218
    s_lshl_b32 s52, s46, 9
    s_add_u32 s52, s52, 0x10000
    v_add_u32 v222, s52, v219
    s_lshl_b32 s52, s53, 9
    s_add_u32 s52, s52, 0x10000
    v_add_u32 v223, s52, v219
    ds_write_b64 v222, v[214:215]
    s_cmp_eq_u32 s58, 0
    s_cbranch_scc0 gqa_attn_kernel_mh1
    s_nop 15
    ds_write_b128 v220, v[32:35] offset:0
    ds_write_b128 v220, v[36:39] offset:1024
    ds_write_b128 v220, v[40:43] offset:2048
    ds_write_b128 v220, v[44:47] offset:3072
    ds_write_b128 v220, v[48:51] offset:4096
    ds_write_b128 v220, v[52:55] offset:5120
    ds_write_b128 v220, v[56:59] offset:6144
    ds_write_b128 v220, v[60:63] offset:7168
    s_waitcnt lgkmcnt(0)
    s_branch gqa_attn_kernel_mjoin
gqa_attn_kernel_mh1:
    ds_write_b128 v220, v[0:3] offset:0
    ds_write_b128 v220, v[4:7] offset:1024
    ds_write_b128 v220, v[8:11] offset:2048
    ds_write_b128 v220, v[12:15] offset:3072
    ds_write_b128 v220, v[16:19] offset:4096
    ds_write_b128 v220, v[20:23] offset:5120
    ds_write_b128 v220, v[24:27] offset:6144
    ds_write_b128 v220, v[28:31] offset:7168
    s_waitcnt lgkmcnt(0)
    v_mov_b32 v0, v32
    v_mov_b32 v1, v33
    v_mov_b32 v2, v34
    v_mov_b32 v3, v35
    v_mov_b32 v4, v36
    v_mov_b32 v5, v37
    v_mov_b32 v6, v38
    v_mov_b32 v7, v39
    v_mov_b32 v8, v40
    v_mov_b32 v9, v41
    v_mov_b32 v10, v42
    v_mov_b32 v11, v43
    v_mov_b32 v12, v44
    v_mov_b32 v13, v45
    v_mov_b32 v14, v46
    v_mov_b32 v15, v47
    v_mov_b32 v16, v48
    v_mov_b32 v17, v49
    v_mov_b32 v18, v50
    v_mov_b32 v19, v51
    v_mov_b32 v20, v52
    v_mov_b32 v21, v53
    v_mov_b32 v22, v54
    v_mov_b32 v23, v55
    v_mov_b32 v24, v56
    v_mov_b32 v25, v57
    v_mov_b32 v26, v58
    v_mov_b32 v27, v59
    v_mov_b32 v28, v60
    v_mov_b32 v29, v61
    v_mov_b32 v30, v62
    v_mov_b32 v31, v63
gqa_attn_kernel_mjoin:
    s_nop 1
    s_barrier
    ds_read_b64 v[224:225], v223
    ds_read_b128 v[96:99], v221 offset:0
    ds_read_b128 v[100:103], v221 offset:1024
    ds_read_b128 v[104:107], v221 offset:2048
    ds_read_b128 v[108:111], v221 offset:3072
    ds_read_b128 v[112:115], v221 offset:4096
    ds_read_b128 v[116:119], v221 offset:5120
    ds_read_b128 v[120:123], v221 offset:6144
    ds_read_b128 v[124:127], v221 offset:7168
    s_waitcnt lgkmcnt(8)
    v_max_f32 v226, v211, v225
    v_sub_f32 v227, v211, v226
    v_sub_f32 v228, v225, v226
    v_mul_f32 v227, s51, v227
    v_mul_f32 v228, s51, v228
    v_exp_f32 v227, v227
    v_exp_f32 v228, v228
    v_mul_f32 v226, v214, v227
    v_fma_f32 v226, v224, v228, v226
    v_rcp_f32 v226, v226
    s_nop 0
    v_mul_f32 v227, v227, v226
    v_mul_f32 v228, v228, v226
    v_mul_f32 v0, v0, v227
    s_waitcnt lgkmcnt(7)
    v_fma_f32 v0, v96, v228, v0
    v_mul_f32 v1, v1, v227
    v_fma_f32 v1, v97, v228, v1
    v_mul_f32 v2, v2, v227
    v_fma_f32 v2, v98, v228, v2
    v_mul_f32 v3, v3, v227
    v_fma_f32 v3, v99, v228, v3
    v_mul_f32 v4, v4, v227
    s_waitcnt lgkmcnt(6)
    v_fma_f32 v4, v100, v228, v4
    v_mul_f32 v5, v5, v227
    v_fma_f32 v5, v101, v228, v5
    v_mul_f32 v6, v6, v227
    v_fma_f32 v6, v102, v228, v6
    v_mul_f32 v7, v7, v227
    v_fma_f32 v7, v103, v228, v7
    v_cvt_pk_bf16_f32 v160, v0, v1
    v_cvt_pk_bf16_f32 v161, v2, v3
    v_cvt_pk_bf16_f32 v162, v4, v5
    v_cvt_pk_bf16_f32 v163, v6, v7
    buffer_store_dwordx4 v[160:163], v210, s[36:39], 0 offen offset:0
    v_mul_f32 v8, v8, v227
    s_waitcnt lgkmcnt(5)
    v_fma_f32 v8, v104, v228, v8
    v_mul_f32 v9, v9, v227
    v_fma_f32 v9, v105, v228, v9
    v_mul_f32 v10, v10, v227
    v_fma_f32 v10, v106, v228, v10
    v_mul_f32 v11, v11, v227
    v_fma_f32 v11, v107, v228, v11
    v_mul_f32 v12, v12, v227
    s_waitcnt lgkmcnt(4)
    v_fma_f32 v12, v108, v228, v12
    v_mul_f32 v13, v13, v227
    v_fma_f32 v13, v109, v228, v13
    v_mul_f32 v14, v14, v227
    v_fma_f32 v14, v110, v228, v14
    v_mul_f32 v15, v15, v227
    v_fma_f32 v15, v111, v228, v15
    v_cvt_pk_bf16_f32 v164, v8, v9
    v_cvt_pk_bf16_f32 v165, v10, v11
    v_cvt_pk_bf16_f32 v166, v12, v13
    v_cvt_pk_bf16_f32 v167, v14, v15
    buffer_store_dwordx4 v[164:167], v210, s[36:39], 0 offen offset:512
    v_mul_f32 v16, v16, v227
    s_waitcnt lgkmcnt(3)
    v_fma_f32 v16, v112, v228, v16
    v_mul_f32 v17, v17, v227
    v_fma_f32 v17, v113, v228, v17
    v_mul_f32 v18, v18, v227
    v_fma_f32 v18, v114, v228, v18
    v_mul_f32 v19, v19, v227
    v_fma_f32 v19, v115, v228, v19
    v_mul_f32 v20, v20, v227
    s_waitcnt lgkmcnt(2)
    v_fma_f32 v20, v116, v228, v20
    v_mul_f32 v21, v21, v227
    v_fma_f32 v21, v117, v228, v21
    v_mul_f32 v22, v22, v227
    v_fma_f32 v22, v118, v228, v22
    v_mul_f32 v23, v23, v227
    v_fma_f32 v23, v119, v228, v23
    v_cvt_pk_bf16_f32 v168, v16, v17
    v_cvt_pk_bf16_f32 v169, v18, v19
    v_cvt_pk_bf16_f32 v170, v20, v21
    v_cvt_pk_bf16_f32 v171, v22, v23
    buffer_store_dwordx4 v[168:171], v210, s[36:39], 0 offen offset:1024
    v_mul_f32 v24, v24, v227
    s_waitcnt lgkmcnt(1)
    v_fma_f32 v24, v120, v228, v24
    v_mul_f32 v25, v25, v227
    v_fma_f32 v25, v121, v228, v25
    v_mul_f32 v26, v26, v227
    v_fma_f32 v26, v122, v228, v26
    v_mul_f32 v27, v27, v227
    v_fma_f32 v27, v123, v228, v27
    v_mul_f32 v28, v28, v227
    s_waitcnt lgkmcnt(0)
    v_fma_f32 v28, v124, v228, v28
    v_mul_f32 v29, v29, v227
    v_fma_f32 v29, v125, v228, v29
    v_mul_f32 v30, v30, v227
    v_fma_f32 v30, v126, v228, v30
    v_mul_f32 v31, v31, v227
    v_fma_f32 v31, v127, v228, v31
    v_cvt_pk_bf16_f32 v172, v24, v25
    v_cvt_pk_bf16_f32 v173, v26, v27
    v_cvt_pk_bf16_f32 v174, v28, v29
    v_cvt_pk_bf16_f32 v175, v30, v31
    buffer_store_dwordx4 v[172:175], v210, s[36:39], 0 offen offset:1536
gqa_attn_kernel_done:
    s_endpgm
gqa_attn_kernel_rare1:
    s_nop 15
    s_nop 15
    v_max_f32 v220, v211, v216
    v_sub_f32 v221, v211, v220
    v_mul_f32 v221, s51, v221
    v_exp_f32 v221, v221
    v_mov_b32 v211, v220
    v_mul_f32 v212, s51, v220
    v_add_f32 v213, 0x427af233, v220
    v_mul_f32 v214, v214, v221
    v_mul_f32 v215, v215, v221
    v_mul_f32 v0, v0, v221
    v_mul_f32 v1, v1, v221
    v_mul_f32 v2, v2, v221
    v_mul_f32 v3, v3, v221
    v_mul_f32 v4, v4, v221
    v_mul_f32 v5, v5, v221
    v_mul_f32 v6, v6, v221
    v_mul_f32 v7, v7, v221
    v_mul_f32 v8, v8, v221
    v_mul_f32 v9, v9, v221
    v_mul_f32 v10, v10, v221
    v_mul_f32 v11, v11, v221
    v_mul_f32 v12, v12, v221
    v_mul_f32 v13, v13, v221
    v_mul_f32 v14, v14, v221
    v_mul_f32 v15, v15, v221
    v_mul_f32 v16, v16, v221
    v_mul_f32 v17, v17, v221
    v_mul_f32 v18, v18, v221
    v_mul_f32 v19, v19, v221
    v_mul_f32 v20, v20, v221
    v_mul_f32 v21, v21, v221
    v_mul_f32 v22, v22, v221
    v_mul_f32 v23, v23, v221
    v_mul_f32 v24, v24, v221
    v_mul_f32 v25, v25, v221
    v_mul_f32 v26, v26, v221
    v_mul_f32 v27, v27, v221
    v_mul_f32 v28, v28, v221
    v_mul_f32 v29, v29, v221
    v_mul_f32 v30, v30, v221
    v_mul_f32 v31, v31, v221
    v_mul_f32 v32, v32, v221
    v_mul_f32 v33, v33, v221
    v_mul_f32 v34, v34, v221
    v_mul_f32 v35, v35, v221
    v_mul_f32 v36, v36, v221
    v_mul_f32 v37, v37, v221
    v_mul_f32 v38, v38, v221
    v_mul_f32 v39, v39, v221
    v_mul_f32 v40, v40, v221
    v_mul_f32 v41, v41, v221
    v_mul_f32 v42, v42, v221
    v_mul_f32 v43, v43, v221
    v_mul_f32 v44, v44, v221
    v_mul_f32 v45, v45, v221
    v_mul_f32 v46, v46, v221
    v_mul_f32 v47, v47, v221
    v_mul_f32 v48, v48, v221
    v_mul_f32 v49, v49, v221
    v_mul_f32 v50, v50, v221
    v_mul_f32 v51, v51, v221
    v_mul_f32 v52, v52, v221
    v_mul_f32 v53, v53, v221
    v_mul_f32 v54, v54, v221
    v_mul_f32 v55, v55, v221
    v_mul_f32 v56, v56, v221
    v_mul_f32 v57, v57, v221
    v_mul_f32 v58, v58, v221
    v_mul_f32 v59, v59, v221
    v_mul_f32 v60, v60, v221
    v_mul_f32 v61, v61, v221
    v_mul_f32 v62, v62, v221
    v_mul_f32 v63, v63, v221
    s_nop 3
    s_branch gqa_attn_kernel_back1
gqa_attn_kernel_rare2:
    s_nop 15
    s_nop 15
    v_max_f32 v220, v211, v216
    v_sub_f32 v221, v211, v220
    v_mul_f32 v221, s51, v221
    v_exp_f32 v221, v221
    v_mov_b32 v211, v220
    v_mul_f32 v212, s51, v220
    v_add_f32 v213, 0x427af233, v220
    v_mul_f32 v214, v214, v221
    v_mul_f32 v215, v215, v221
    v_mul_f32 v0, v0, v221
    v_mul_f32 v1, v1, v221
    v_mul_f32 v2, v2, v221
    v_mul_f32 v3, v3, v221
    v_mul_f32 v4, v4, v221
    v_mul_f32 v5, v5, v221
    v_mul_f32 v6, v6, v221
    v_mul_f32 v7, v7, v221
    v_mul_f32 v8, v8, v221
    v_mul_f32 v9, v9, v221
    v_mul_f32 v10, v10, v221
    v_mul_f32 v11, v11, v221
    v_mul_f32 v12, v12, v221
    v_mul_f32 v13, v13, v221
    v_mul_f32 v14, v14, v221
    v_mul_f32 v15, v15, v221
    v_mul_f32 v16, v16, v221
    v_mul_f32 v17, v17, v221
    v_mul_f32 v18, v18, v221
    v_mul_f32 v19, v19, v221
    v_mul_f32 v20, v20, v221
    v_mul_f32 v21, v21, v221
    v_mul_f32 v22, v22, v221
    v_mul_f32 v23, v23, v221
    v_mul_f32 v24, v24, v221
    v_mul_f32 v25, v25, v221
    v_mul_f32 v26, v26, v221
    v_mul_f32 v27, v27, v221
    v_mul_f32 v28, v28, v221
    v_mul_f32 v29, v29, v221
    v_mul_f32 v30, v30, v221
    v_mul_f32 v31, v31, v221
    v_mul_f32 v32, v32, v221
    v_mul_f32 v33, v33, v221
    v_mul_f32 v34, v34, v221
    v_mul_f32 v35, v35, v221
    v_mul_f32 v36, v36, v221
    v_mul_f32 v37, v37, v221
    v_mul_f32 v38, v38, v221
    v_mul_f32 v39, v39, v221
    v_mul_f32 v40, v40, v221
    v_mul_f32 v41, v41, v221
    v_mul_f32 v42, v42, v221
    v_mul_f32 v43, v43, v221
    v_mul_f32 v44, v44, v221
    v_mul_f32 v45, v45, v221
    v_mul_f32 v46, v46, v221
    v_mul_f32 v47, v47, v221
    v_mul_f32 v48, v48, v221
    v_mul_f32 v49, v49, v221
    v_mul_f32 v50, v50, v221
    v_mul_f32 v51, v51, v221
    v_mul_f32 v52, v52, v221
    v_mul_f32 v53, v53, v221
    v_mul_f32 v54, v54, v221
    v_mul_f32 v55, v55, v221
    v_mul_f32 v56, v56, v221
    v_mul_f32 v57, v57, v221
    v_mul_f32 v58, v58, v221
    v_mul_f32 v59, v59, v221
    v_mul_f32 v60, v60, v221
    v_mul_f32 v61, v61, v221
    v_mul_f32 v62, v62, v221
    v_mul_f32 v63, v63, v221
    s_nop 3
    s_branch gqa_attn_kernel_back2
gqa_attn_kernel_rare3:
    s_nop 15
    s_nop 15
    v_max_f32 v220, v211, v216
    v_sub_f32 v221, v211, v220
    v_mul_f32 v221, s51, v221
    v_exp_f32 v221, v221
    v_mov_b32 v211, v220
    v_mul_f32 v212, s51, v220
    v_add_f32 v213, 0x427af233, v220
    v_mul_f32 v214, v214, v221
    v_mul_f32 v215, v215, v221
    v_mul_f32 v0, v0, v221
    v_mul_f32 v1, v1, v221
    v_mul_f32 v2, v2, v221
    v_mul_f32 v3, v3, v221
    v_mul_f32 v4, v4, v221
    v_mul_f32 v5, v5, v221
    v_mul_f32 v6, v6, v221
    v_mul_f32 v7, v7, v221
    v_mul_f32 v8, v8, v221
    v_mul_f32 v9, v9, v221
    v_mul_f32 v10, v10, v221
    v_mul_f32 v11, v11, v221
    v_mul_f32 v12, v12, v221
    v_mul_f32 v13, v13, v221
    v_mul_f32 v14, v14, v221
    v_mul_f32 v15, v15, v221
    v_mul_f32 v16, v16, v221
    v_mul_f32 v17, v17, v221
    v_mul_f32 v18, v18, v221
    v_mul_f32 v19, v19, v221
    v_mul_f32 v20, v20, v221
    v_mul_f32 v21, v21, v221
    v_mul_f32 v22, v22, v221
    v_mul_f32 v23, v23, v221
    v_mul_f32 v24, v24, v221
    v_mul_f32 v25, v25, v221
    v_mul_f32 v26, v26, v221
    v_mul_f32 v27, v27, v221
    v_mul_f32 v28, v28, v221
    v_mul_f32 v29, v29, v221
    v_mul_f32 v30, v30, v221
    v_mul_f32 v31, v31, v221
    v_mul_f32 v32, v32, v221
    v_mul_f32 v33, v33, v221
    v_mul_f32 v34, v34, v221
    v_mul_f32 v35, v35, v221
    v_mul_f32 v36, v36, v221
    v_mul_f32 v37, v37, v221
    v_mul_f32 v38, v38, v221
    v_mul_f32 v39, v39, v221
    v_mul_f32 v40, v40, v221
    v_mul_f32 v41, v41, v221
    v_mul_f32 v42, v42, v221
    v_mul_f32 v43, v43, v221
    v_mul_f32 v44, v44, v221
    v_mul_f32 v45, v45, v221
    v_mul_f32 v46, v46, v221
    v_mul_f32 v47, v47, v221
    v_mul_f32 v48, v48, v221
    v_mul_f32 v49, v49, v221
    v_mul_f32 v50, v50, v221
    v_mul_f32 v51, v51, v221
    v_mul_f32 v52, v52, v221
    v_mul_f32 v53, v53, v221
    v_mul_f32 v54, v54, v221
    v_mul_f32 v55, v55, v221
    v_mul_f32 v56, v56, v221
    v_mul_f32 v57, v57, v221
    v_mul_f32 v58, v58, v221
    v_mul_f32 v59, v59, v221
    v_mul_f32 v60, v60, v221
    v_mul_f32 v61, v61, v221
    v_mul_f32 v62, v62, v221
    v_mul_f32 v63, v63, v221
    s_nop 3
    s_branch gqa_attn_kernel_back3

.globl gqa_oproj_kernel
.p2align 8
.type gqa_oproj_kernel,@function
gqa_oproj_kernel:
    s_cmp_ge_u32 s2, 256
    s_cbranch_scc1 gqa_oproj_kernel_done
    s_and_b32 s40, s2, 7
    s_lshr_b32 s41, s2, 3
    s_lshl_b32 s40, s40, 5
    s_add_u32 s40, s40, s41
    s_cmp_ge_u32 s40, 252
    s_cbranch_scc1 gqa_oproj_kernel_done
    s_load_dwordx4 s[12:15], s[0:1], 32
    s_load_dwordx4 s[16:19], s[0:1], 48
    s_mul_i32 s42, s40, 7282
    s_lshr_b32 s42, s42, 16
    s_mul_i32 s43, s42, 9
    s_sub_u32 s43, s40, s43
    v_lshrrev_b32 v118, 6, v0
    v_and_b32 v119, 63, v0
    v_readfirstlane_b32 s46, v118
    v_and_b32 v120, 31, v119
    v_lshrrev_b32 v121, 5, v119
    v_bfe_u32 v122, v119, 4, 1
    v_bfe_u32 v123, v119, 2, 2
    v_and_b32 v124, 3, v119
    v_lshrrev_b32 v125, 3, v119
    s_movk_i32 s55, 1152
    v_mul_lo_u32 v125, v125, s55
    v_and_b32 v126, 7, v119
    v_lshlrev_b32 v127, 2, v122
    v_xor_b32 v126, v126, v127
    v_lshl_add_u32 v112, v126, 4, v125
    s_mul_i32 s47, s46, 36864
    s_lshl_b32 s52, s43, 7
    s_add_u32 s47, s47, s52
    s_mul_i32 s49, s46, 10240
    s_lshl_b32 s52, s42, 1
    v_lshrrev_b32 v125, 4, v120
    v_add_u32 v125, s52, v125
    v_lshlrev_b32 v125, 9, v125
    v_add_u32 v125, v125, v121
    v_lshlrev_b32 v125, 8, v125
    v_and_b32 v126, 15, v120
    v_lshl_add_u32 v113, v126, 4, v125
    s_mul_i32 s48, s46, 1024
    v_lshl_add_u32 v125, v121, 2, v123
    v_lshlrev_b32 v125, 7, v125
    v_lshl_add_u32 v125, v122, 5, v125
    v_lshl_add_u32 v125, v124, 3, v125
    v_add_u32 v125, s49, v125
    v_lshrrev_b32 v126, 1, v123
    v_xor_b32 v127, 0, v126
    v_lshl_add_u32 v114, v127, 6, v125
    v_xor_b32 v127, 1, v126
    v_lshl_add_u32 v115, v127, 6, v125
    s_lshl_b32 s52, s42, 5
    v_add_u32 v125, s52, v120
    v_mul_lo_u32 v125, v125, s55
    v_lshl_add_u32 v125, v121, 3, v125
    s_lshl_b32 s52, s43, 7
    s_lshr_b32 s53, s46, 1
    s_lshl_b32 s53, s53, 4
    s_add_u32 s52, s52, s53
    s_and_b32 s53, s46, 1
    s_lshl_b32 s53, s53, 2
    s_add_u32 s52, s52, s53
    v_add_u32 v116, s52, v125
    v_lshlrev_b32 v117, 4, v119
    s_waitcnt lgkmcnt(0)
    s_mov_b32 s20, s12
    s_and_b32 s21, s13, 0xffff
    s_mov_b32 s22, 4718592
    s_mov_b32 s23, 0x00020000
    s_mov_b32 s24, s18
    s_and_b32 s25, s19, 0xffff
    s_mov_b32 s26, 7340032
    s_mov_b32 s27, 0x00020000
    s_mov_b32 s28, s14
    s_and_b32 s29, s15, 0xffff
    s_mov_b32 s30, 1032192
    s_mov_b32 s31, 0x00020000
    s_add_u32 s50, s47, 0x0
    s_add_u32 m0, s49, 0x0
    s_nop 0
    buffer_load_dwordx4 v112, s[20:23], s50 offen lds
    s_add_u32 s50, s47, 0x2400
    s_add_u32 m0, s49, 0x400
    s_nop 0
    buffer_load_dwordx4 v112, s[20:23], s50 offen lds
    s_add_u32 s50, s47, 0x4800
    s_add_u32 m0, s49, 0x800
    s_nop 0
    buffer_load_dwordx4 v112, s[20:23], s50 offen lds
    s_add_u32 s50, s47, 0x6c00
    s_add_u32 m0, s49, 0xc00
    s_nop 0
    buffer_load_dwordx4 v112, s[20:23], s50 offen lds
    s_add_u32 s51, s48, 0x0
    buffer_load_dwordx4 v[32:35], v113, s[24:27], s51 offen
    buffer_load_dwordx4 v[36:39], v113, s[24:27], s51 offen offset:512
    s_add_u32 s50, s47, 0x90000
    s_add_u32 m0, s49, 0x1000
    s_nop 0
    buffer_load_dwordx4 v112, s[20:23], s50 offen lds
    s_add_u32 s50, s47, 0x92400
    s_add_u32 m0, s49, 0x1400
    s_nop 0
    buffer_load_dwordx4 v112, s[20:23], s50 offen lds
    s_add_u32 s50, s47, 0x94800
    s_add_u32 m0, s49, 0x1800
    s_nop 0
    buffer_load_dwordx4 v112, s[20:23], s50 offen lds
    s_add_u32 s50, s47, 0x96c00
    s_add_u32 m0, s49, 0x1c00
    s_nop 0
    buffer_load_dwordx4 v112, s[20:23], s50 offen lds
    s_add_u32 s51, s48, 0x4000
    buffer_load_dwordx4 v[40:43], v113, s[24:27], s51 offen
    buffer_load_dwordx4 v[44:47], v113, s[24:27], s51 offen offset:512
    s_add_u32 s51, s48, 0x8000
    buffer_load_dwordx4 v[48:51], v113, s[24:27], s51 offen
    buffer_load_dwordx4 v[52:55], v113, s[24:27], s51 offen offset:512
    s_add_u32 s51, s48, 0xc000
    buffer_load_dwordx4 v[56:59], v113, s[24:27], s51 offen
    buffer_load_dwordx4 v[60:63], v113, s[24:27], s51 offen offset:512
    s_add_u32 s51, s48, 0x10000
    buffer_load_dwordx4 v[64:67], v113, s[24:27], s51 offen
    buffer_load_dwordx4 v[68:71], v113, s[24:27], s51 offen offset:512
    s_add_u32 s51, s48, 0x14000
    buffer_load_dwordx4 v[72:75], v113, s[24:27], s51 offen
    buffer_load_dwordx4 v[76:79], v113, s[24:27], s51 offen offset:512
    s_add_u32 s51, s48, 0x18000
    buffer_load_dwordx4 v[80:83], v113, s[24:27], s51 offen
    buffer_load_dwordx4 v[84:87], v113, s[24:27], s51 offen offset:512
    s_add_u32 s51, s48, 0x1c000
    buffer_load_dwordx4 v[88:91], v113, s[24:27], s51 offen
    buffer_load_dwordx4 v[92:95], v113, s[24:27], s51 offen offset:512
    s_waitcnt vmcnt(20)
    ds_read_b64_tr_b16 v[96:97], v114 offset:0
    ds_read_b64_tr_b16 v[98:99], v114 offset:1024
    ds_read_b64_tr_b16 v[100:101], v115 offset:0
    ds_read_b64_tr_b16 v[102:103], v115 offset:1024
    ds_read_b64_tr_b16 v[104:105], v114 offset:2048
    ds_read_b64_tr_b16 v[106:107], v114 offset:3072
    ds_read_b64_tr_b16 v[108:109], v115 offset:2048
    ds_read_b64_tr_b16 v[110:111], v115 offset:3072
    s_waitcnt lgkmcnt(6)
    s_waitcnt vmcnt(19)
    v_mfma_f32_32x32x16_bf16 v[0:15], v[96:99], v[32:35], 0
    s_waitcnt lgkmcnt(4)
    v_mfma_f32_32x32x16_bf16 v[16:31], v[100:103], v[32:35], 0
    s_waitcnt lgkmcnt(2)
    s_waitcnt vmcnt(18)
    v_mfma_f32_32x32x16_bf16 v[0:15], v[104:107], v[36:39], v[0:15]
    s_waitcnt lgkmcnt(0)
    v_mfma_f32_32x32x16_bf16 v[16:31], v[108:111], v[36:39], v[16:31]
    s_add_u32 s50, s47, 0x120000
    s_add_u32 m0, s49, 0x0
    s_nop 0
    buffer_load_dwordx4 v112, s[20:23], s50 offen lds
    s_add_u32 s50, s47, 0x122400
    s_add_u32 m0, s49, 0x400
    s_nop 0
    buffer_load_dwordx4 v112, s[20:23], s50 offen lds
    s_add_u32 s50, s47, 0x124800
    s_add_u32 m0, s49, 0x800
    s_nop 0
    buffer_load_dwordx4 v112, s[20:23], s50 offen lds
    s_add_u32 s50, s47, 0x126c00
    s_add_u32 m0, s49, 0xc00
    s_nop 0
    buffer_load_dwordx4 v112, s[20:23], s50 offen lds
    s_waitcnt vmcnt(18)
    ds_read_b64_tr_b16 v[96:97], v114 offset:4096
    ds_read_b64_tr_b16 v[98:99], v114 offset:5120
    ds_read_b64_tr_b16 v[100:101], v115 offset:4096
    ds_read_b64_tr_b16 v[102:103], v115 offset:5120
    ds_read_b64_tr_b16 v[104:105], v114 offset:6144
    ds_read_b64_tr_b16 v[106:107], v114 offset:7168
    ds_read_b64_tr_b16 v[108:109], v115 offset:6144
    ds_read_b64_tr_b16 v[110:111], v115 offset:7168
    s_waitcnt lgkmcnt(6)
    s_waitcnt vmcnt(17)
    v_mfma_f32_32x32x16_bf16 v[0:15], v[96:99], v[40:43], v[0:15]
    s_waitcnt lgkmcnt(4)
    v_mfma_f32_32x32x16_bf16 v[16:31], v[100:103], v[40:43], v[16:31]
    s_waitcnt lgkmcnt(2)
    s_waitcnt vmcnt(16)
    v_mfma_f32_32x32x16_bf16 v[0:15], v[104:107], v[44:47], v[0:15]
    s_waitcnt lgkmcnt(0)
    v_mfma_f32_32x32x16_bf16 v[16:31], v[108:111], v[44:47], v[16:31]
    s_add_u32 s50, s47, 0x1b0000
    s_add_u32 m0, s49, 0x1000
    s_nop 0
    buffer_load_dwordx4 v112, s[20:23], s50 offen lds
    s_add_u32 s50, s47, 0x1b2400
    s_add_u32 m0, s49, 0x1400
    s_nop 0
    buffer_load_dwordx4 v112, s[20:23], s50 offen lds
    s_add_u32 s50, s47, 0x1b4800
    s_add_u32 m0, s49, 0x1800
    s_nop 0
    buffer_load_dwordx4 v112, s[20:23], s50 offen lds
    s_add_u32 s50, s47, 0x1b6c00
    s_add_u32 m0, s49, 0x1c00
    s_nop 0
    buffer_load_dwordx4 v112, s[20:23], s50 offen lds
    s_waitcnt vmcnt(4)
    ds_read_b64_tr_b16 v[96:97], v114 offset:0
    ds_read_b64_tr_b16 v[98:99], v114 offset:1024
    ds_read_b64_tr_b16 v[100:101], v115 offset:0
    ds_read_b64_tr_b16 v[102:103], v115 offset:1024
    ds_read_b64_tr_b16 v[104:105], v114 offset:2048
    ds_read_b64_tr_b16 v[106:107], v114 offset:3072
    ds_read_b64_tr_b16 v[108:109], v115 offset:2048
    ds_read_b64_tr_b16 v[110:111], v115 offset:3072
    s_waitcnt lgkmcnt(6)
    v_mfma_f32_32x32x16_bf16 v[0:15], v[96:99], v[48:51], v[0:15]
    s_waitcnt lgkmcnt(4)
    v_mfma_f32_32x32x16_bf16 v[16:31], v[100:103], v[48:51], v[16:31]
    s_waitcnt lgkmcnt(2)
    v_mfma_f32_32x32x16_bf16 v[0:15], v[104:107], v[52:55], v[0:15]
    s_waitcnt lgkmcnt(0)
    v_mfma_f32_32x32x16_bf16 v[16:31], v[108:111], v[52:55], v[16:31]
    s_add_u32 s50, s47, 0x240000
    s_add_u32 m0, s49, 0x0
    s_nop 0
    buffer_load_dwordx4 v112, s[20:23], s50 offen lds
    s_add_u32 s50, s47, 0x242400
    s_add_u32 m0, s49, 0x400
    s_nop 0
    buffer_load_dwordx4 v112, s[20:23], s50 offen lds
    s_add_u32 s50, s47, 0x244800
    s_add_u32 m0, s49, 0x800
    s_nop 0
    buffer_load_dwordx4 v112, s[20:23], s50 offen lds
    s_add_u32 s50, s47, 0x246c00
    s_add_u32 m0, s49, 0xc00
    s_nop 0
    buffer_load_dwordx4 v112, s[20:23], s50 offen lds
    s_waitcnt vmcnt(4)
    ds_read_b64_tr_b16 v[96:97], v114 offset:4096
    ds_read_b64_tr_b16 v[98:99], v114 offset:5120
    ds_read_b64_tr_b16 v[100:101], v115 offset:4096
    ds_read_b64_tr_b16 v[102:103], v115 offset:5120
    ds_read_b64_tr_b16 v[104:105], v114 offset:6144
    ds_read_b64_tr_b16 v[106:107], v114 offset:7168
    ds_read_b64_tr_b16 v[108:109], v115 offset:6144
    ds_read_b64_tr_b16 v[110:111], v115 offset:7168
    s_waitcnt lgkmcnt(6)
    v_mfma_f32_32x32x16_bf16 v[0:15], v[96:99], v[56:59], v[0:15]
    s_waitcnt lgkmcnt(4)
    v_mfma_f32_32x32x16_bf16 v[16:31], v[100:103], v[56:59], v[16:31]
    s_waitcnt lgkmcnt(2)
    v_mfma_f32_32x32x16_bf16 v[0:15], v[104:107], v[60:63], v[0:15]
    s_waitcnt lgkmcnt(0)
    v_mfma_f32_32x32x16_bf16 v[16:31], v[108:111], v[60:63], v[16:31]
    s_add_u32 s50, s47, 0x2d0000
    s_add_u32 m0, s49, 0x1000
    s_nop 0
    buffer_load_dwordx4 v112, s[20:23], s50 offen lds
    s_add_u32 s50, s47, 0x2d2400
    s_add_u32 m0, s49, 0x1400
    s_nop 0
    buffer_load_dwordx4 v112, s[20:23], s50 offen lds
    s_add_u32 s50, s47, 0x2d4800
    s_add_u32 m0, s49, 0x1800
    s_nop 0
    buffer_load_dwordx4 v112, s[20:23], s50 offen lds
    s_add_u32 s50, s47, 0x2d6c00
    s_add_u32 m0, s49, 0x1c00
    s_nop 0
    buffer_load_dwordx4 v112, s[20:23], s50 offen lds
    s_waitcnt vmcnt(4)
    ds_read_b64_tr_b16 v[96:97], v114 offset:0
    ds_read_b64_tr_b16 v[98:99], v114 offset:1024
    ds_read_b64_tr_b16 v[100:101], v115 offset:0
    ds_read_b64_tr_b16 v[102:103], v115 offset:1024
    ds_read_b64_tr_b16 v[104:105], v114 offset:2048
    ds_read_b64_tr_b16 v[106:107], v114 offset:3072
    ds_read_b64_tr_b16 v[108:109], v115 offset:2048
    ds_read_b64_tr_b16 v[110:111], v115 offset:3072
    s_waitcnt lgkmcnt(6)
    v_mfma_f32_32x32x16_bf16 v[0:15], v[96:99], v[64:67], v[0:15]
    s_waitcnt lgkmcnt(4)
    v_mfma_f32_32x32x16_bf16 v[16:31], v[100:103], v[64:67], v[16:31]
    s_waitcnt lgkmcnt(2)
    v_mfma_f32_32x32x16_bf16 v[0:15], v[104:107], v[68:71], v[0:15]
    s_waitcnt lgkmcnt(0)
    v_mfma_f32_32x32x16_bf16 v[16:31], v[108:111], v[68:71], v[16:31]
    s_add_u32 s50, s47, 0x360000
    s_add_u32 m0, s49, 0x0
    s_nop 0
    buffer_load_dwordx4 v112, s[20:23], s50 offen lds
    s_add_u32 s50, s47, 0x362400
    s_add_u32 m0, s49, 0x400
    s_nop 0
    buffer_load_dwordx4 v112, s[20:23], s50 offen lds
    s_add_u32 s50, s47, 0x364800
    s_add_u32 m0, s49, 0x800
    s_nop 0
    buffer_load_dwordx4 v112, s[20:23], s50 offen lds
    s_add_u32 s50, s47, 0x366c00
    s_add_u32 m0, s49, 0xc00
    s_nop 0
    buffer_load_dwordx4 v112, s[20:23], s50 offen lds
    s_waitcnt vmcnt(4)
    ds_read_b64_tr_b16 v[96:97], v114 offset:4096
    ds_read_b64_tr_b16 v[98:99], v114 offset:5120
    ds_read_b64_tr_b16 v[100:101], v115 offset:4096
    ds_read_b64_tr_b16 v[102:103], v115 offset:5120
    ds_read_b64_tr_b16 v[104:105], v114 offset:6144
    ds_read_b64_tr_b16 v[106:107], v114 offset:7168
    ds_read_b64_tr_b16 v[108:109], v115 offset:6144
    ds_read_b64_tr_b16 v[110:111], v115 offset:7168
    s_waitcnt lgkmcnt(6)
    v_mfma_f32_32x32x16_bf16 v[0:15], v[96:99], v[72:75], v[0:15]
    s_waitcnt lgkmcnt(4)
    v_mfma_f32_32x32x16_bf16 v[16:31], v[100:103], v[72:75], v[16:31]
    s_waitcnt lgkmcnt(2)
    v_mfma_f32_32x32x16_bf16 v[0:15], v[104:107], v[76:79], v[0:15]
    s_waitcnt lgkmcnt(0)
    v_mfma_f32_32x32x16_bf16 v[16:31], v[108:111], v[76:79], v[16:31]
    s_add_u32 s50, s47, 0x3f0000
    s_add_u32 m0, s49, 0x1000
    s_nop 0
    buffer_load_dwordx4 v112, s[20:23], s50 offen lds
    s_add_u32 s50, s47, 0x3f2400
    s_add_u32 m0, s49, 0x1400
    s_nop 0
    buffer_load_dwordx4 v112, s[20:23], s50 offen lds
    s_add_u32 s50, s47, 0x3f4800
    s_add_u32 m0, s49, 0x1800
    s_nop 0
    buffer_load_dwordx4 v112, s[20:23], s50 offen lds
    s_add_u32 s50, s47, 0x3f6c00
    s_add_u32 m0, s49, 0x1c00
    s_nop 0
    buffer_load_dwordx4 v112, s[20:23], s50 offen lds
    s_waitcnt vmcnt(4)
    ds_read_b64_tr_b16 v[96:97], v114 offset:0
    ds_read_b64_tr_b16 v[98:99], v114 offset:1024
    ds_read_b64_tr_b16 v[100:101], v115 offset:0
    ds_read_b64_tr_b16 v[102:103], v115 offset:1024
    ds_read_b64_tr_b16 v[104:105], v114 offset:2048
    ds_read_b64_tr_b16 v[106:107], v114 offset:3072
    ds_read_b64_tr_b16 v[108:109], v115 offset:2048
    ds_read_b64_tr_b16 v[110:111], v115 offset:3072
    s_waitcnt lgkmcnt(6)
    v_mfma_f32_32x32x16_bf16 v[0:15], v[96:99], v[80:83], v[0:15]
    s_waitcnt lgkmcnt(4)
    v_mfma_f32_32x32x16_bf16 v[16:31], v[100:103], v[80:83], v[16:31]
    s_waitcnt lgkmcnt(2)
    v_mfma_f32_32x32x16_bf16 v[0:15], v[104:107], v[84:87], v[0:15]
    s_waitcnt lgkmcnt(0)
    v_mfma_f32_32x32x16_bf16 v[16:31], v[108:111], v[84:87], v[16:31]
    s_waitcnt vmcnt(0)
    ds_read_b64_tr_b16 v[96:97], v114 offset:4096
    ds_read_b64_tr_b16 v[98:99], v114 offset:5120
    ds_read_b64_tr_b16 v[100:101], v115 offset:4096
    ds_read_b64_tr_b16 v[102:103], v115 offset:5120
    ds_read_b64_tr_b16 v[104:105], v114 offset:6144
    ds_read_b64_tr_b16 v[106:107], v114 offset:7168
    ds_read_b64_tr_b16 v[108:109], v115 offset:6144
    ds_read_b64_tr_b16 v[110:111], v115 offset:7168
    s_waitcnt lgkmcnt(6)
    v_mfma_f32_32x32x16_bf16 v[0:15], v[96:99], v[88:91], v[0:15]
    s_waitcnt lgkmcnt(4)
    v_mfma_f32_32x32x16_bf16 v[16:31], v[100:103], v[88:91], v[16:31]
    s_waitcnt lgkmcnt(2)
    v_mfma_f32_32x32x16_bf16 v[0:15], v[104:107], v[92:95], v[0:15]
    s_waitcnt lgkmcnt(0)
    v_mfma_f32_32x32x16_bf16 v[16:31], v[108:111], v[92:95], v[16:31]
    s_barrier
    s_lshl_b32 s52, s46, 13
    v_add_u32 v118, s52, v117
    s_nop 6
    ds_write_b128 v118, v[0:3] offset:0
    ds_write_b128 v118, v[4:7] offset:1024
    ds_write_b128 v118, v[8:11] offset:2048
    ds_write_b128 v118, v[12:15] offset:3072
    ds_write_b128 v118, v[16:19] offset:4096
    ds_write_b128 v118, v[20:23] offset:5120
    ds_write_b128 v118, v[24:27] offset:6144
    ds_write_b128 v118, v[28:31] offset:7168
    s_waitcnt lgkmcnt(0)
    s_barrier
    s_lshr_b32 s52, s46, 1
    s_lshl_b32 s52, s52, 10
    s_and_b32 s53, s46, 1
    s_lshl_b32 s53, s53, 3
    s_add_u32 s52, s52, s53
    v_add_u32 v118, s52, v117
    v_add_u32 v119, 0x10000, v118
    ds_read_b64 v[32:33], v118 offset:0
    ds_read_b64 v[34:35], v118 offset:8192
    ds_read_b64 v[36:37], v118 offset:16384
    ds_read_b64 v[38:39], v118 offset:24576
    ds_read_b64 v[40:41], v118 offset:32768
    ds_read_b64 v[42:43], v118 offset:40960
    ds_read_b64 v[44:45], v118 offset:49152
    ds_read_b64 v[46:47], v118 offset:57344
    ds_read_b64 v[48:49], v119 offset:0
    ds_read_b64 v[50:51], v119 offset:8192
    ds_read_b64 v[52:53], v119 offset:16384
    ds_read_b64 v[54:55], v119 offset:24576
    ds_read_b64 v[56:57], v119 offset:32768
    ds_read_b64 v[58:59], v119 offset:40960
    s_waitcnt lgkmcnt(6)
    ds_read_b64 v[60:61], v119 offset:49152
    ds_read_b64 v[62:63], v119 offset:57344
    s_waitcnt lgkmcnt(7)
    v_add_f32 v32, v32, v48
    v_add_f32 v33, v33, v49
    s_waitcnt lgkmcnt(6)
    v_add_f32 v34, v34, v50
    v_add_f32 v35, v35, v51
    s_waitcnt lgkmcnt(5)
    v_add_f32 v36, v36, v52
    v_add_f32 v37, v37, v53
    s_waitcnt lgkmcnt(4)
    v_add_f32 v38, v38, v54
    v_add_f32 v39, v39, v55
    s_waitcnt lgkmcnt(3)
    v_add_f32 v40, v40, v56
    v_add_f32 v41, v41, v57
    s_waitcnt lgkmcnt(2)
    v_add_f32 v42, v42, v58
    v_add_f32 v43, v43, v59
    s_waitcnt lgkmcnt(1)
    v_add_f32 v44, v44, v60
    v_add_f32 v45, v45, v61
    s_waitcnt lgkmcnt(0)
    v_add_f32 v46, v46, v62
    v_add_f32 v47, v47, v63
    v_add_f32 v32, v32, v40
    v_add_f32 v33, v33, v41
    v_add_f32 v34, v34, v42
    v_add_f32 v35, v35, v43
    v_add_f32 v36, v36, v44
    v_add_f32 v37, v37, v45
    v_add_f32 v38, v38, v46
    v_add_f32 v39, v39, v47
    v_add_f32 v32, v32, v36
    v_add_f32 v33, v33, v37
    v_add_f32 v34, v34, v38
    v_add_f32 v35, v35, v39
    v_add_f32 v32, v32, v34
    v_add_f32 v33, v33, v35
    v_cvt_pk_bf16_f32 v96, v32, v33
    buffer_store_dword v96, v116, s[28:31], 0 offen
gqa_oproj_kernel_done:
    s_endpgm

.section .rodata,"a"
.p2align 6
.amdhsa_kernel gqa_attn_kernel
  .amdhsa_next_free_vgpr 240
  .amdhsa_next_free_sgpr 102
  .amdhsa_accum_offset 240
  .amdhsa_group_segment_fixed_size 0
  .amdhsa_kernarg_size 64
  .amdhsa_user_sgpr_count 2
  .amdhsa_user_sgpr_kernarg_segment_ptr 1
  .amdhsa_system_sgpr_workgroup_id_x 1
  .amdhsa_float_denorm_mode_32 3
.end_amdhsa_kernel

.p2align 6
.amdhsa_kernel gqa_oproj_kernel
  .amdhsa_next_free_vgpr 128
  .amdhsa_next_free_sgpr 102
  .amdhsa_accum_offset 128
  .amdhsa_group_segment_fixed_size 0
  .amdhsa_kernarg_size 64
  .amdhsa_user_sgpr_count 2
  .amdhsa_user_sgpr_kernarg_segment_ptr 1
  .amdhsa_system_sgpr_workgroup_id_x 1
  .amdhsa_float_denorm_mode_32 3
.end_amdhsa_kernel
```
